```python
import torch

def _softmax(x, axis=-1):
    return torch.softmax(x, dim=axis)
def _gelu(x):
    return torch.nn.functional.gelu(x, approximate="tanh")
def _silu(x):
    return torch.nn.functional.silu(x)
def _sigmoid(x):
    return torch.sigmoid(x)
def _layernorm(x, axis=-1, eps=1e-5):
    m = x.mean(dim=axis, keepdim=True)
    v = x.var(dim=axis, keepdim=True, unbiased=False)
    return (x - m) / torch.sqrt(v + eps)
def _scatter_add(tgt, idx, src, axis=0):
    return tgt.clone().index_add_(axis, idx, src)
def _segment_sum(src, seg, n):
    out = torch.zeros((n,) + src.shape[1:], dtype=src.dtype)
    return out.index_add_(0, seg, src)
def _pad(x, pw):
    flat = tuple(v for pair in reversed(pw) for v in pair)
    return torch.nn.functional.pad(x, flat)

kernel_name = 'sequential_preLN__ssm_conv_s4d__mixer_channel_mlp__prompt'

def setup_inputs():

    _w = (lambda a: (lambda t: t.to(torch.bfloat16) if t.is_floating_point() else t)(torch.as_tensor(a)))
    def _A_setup():
        Bsz, L, D, N = 1, 2048, 512, 128
        return {
            "u": _w((lambda *s: torch.randn(*s, dtype=torch.bfloat16) * 0.05)(Bsz, L, D)),
            "log_A_real": _w((lambda *s: torch.randn(*s, dtype=torch.bfloat16) * 3.2)(D, N) * 0.5),
            "A_imag": _w((lambda *s: torch.randn(*s, dtype=torch.bfloat16) * 0.05)(D, N) * 3.14),
            "C_real": _w((lambda *s: torch.randn(*s, dtype=torch.bfloat16) * 0.1)(D, N) / N ** 0.5),
            "C_imag": _w((lambda *s: torch.randn(*s, dtype=torch.bfloat16) * 0.2)(D, N) / N ** 0.5),
            "log_dt": _w((lambda *s: torch.randn(*s, dtype=torch.bfloat16) * 0.05)(D) * 0.5 - 4.0),
            "D_skip": _w((lambda *s: torch.randn(*s, dtype=torch.bfloat16) * 0.05)(D)),
        }
    _A_in = _A_setup()

    def _B_setup():
        B, S, D, F = 1, 2048, 512, 1376
        return {
            "x": _w((lambda *s: torch.randn(*s, dtype=torch.bfloat16) * 0.05)(B, S, D)),
            "w1": _w((lambda *s: torch.randn(*s, dtype=torch.bfloat16) * 1.6)(D, F) * (D ** -0.5)),
            "b1": _w((lambda *s: torch.randn(*s, dtype=torch.bfloat16) * 0.8)(F)),
            "w2": _w((lambda *s: torch.randn(*s, dtype=torch.bfloat16) * 0.05)(F, D) * (F ** -0.5)),
            "b2": _w((lambda *s: torch.randn(*s, dtype=torch.bfloat16) * 0.05)(D)),
        }
    _B_in = _B_setup()

    return {
        "A_u": _A_in["u"],
        "A_log_A_real": _A_in["log_A_real"],
        "A_A_imag": _A_in["A_imag"],
        "A_C_real": _A_in["C_real"],
        "A_C_imag": _A_in["C_imag"],
        "A_log_dt": _A_in["log_dt"],
        "A_D_skip": _A_in["D_skip"],
        "B_x": _B_in["x"],
        "B_w1": _B_in["w1"],
        "B_b1": _B_in["b1"],
        "B_w2": _B_in["w2"],
        "B_b2": _B_in["b2"],
    }

def reference(A_u, A_log_A_real, A_A_imag, A_C_real, A_C_imag, A_log_dt, A_D_skip, B_x, B_w1, B_b1, B_w2, B_b2):
    def _A_ref(u, log_A_real, A_imag, C_real, C_imag, log_dt, D_skip):
        L = u.shape[1]
        dt = torch.exp(log_dt)
        A = -torch.exp(log_A_real) + 1j * A_imag
        C = (C_real + 1j * C_imag) * dt[:, None]
        pos = (lambda x, dt: x.to(dt))(torch.arange(L), log_dt.dtype)
        P = torch.exp((A * dt[:, None])[:, :, None] * pos[None, None, :])
        K = 2.0 * torch.einsum("dn,dnl->dl", C, P).real
        L2 = 2 * L
        u_t = (lambda x, *d: x.permute(*d))(u, 0, 2, 1)
        Kf = (lambda x, *a, **k: torch.fft.rfft(x.float(), *a, **k))(K, L2)
        Uf = (lambda x, *a, **k: torch.fft.rfft(x.float(), *a, **k))(u_t, L2)
        y = (lambda x, *a, **k: torch.fft.irfft(x, *a, **k).to(torch.bfloat16))(Uf * Kf[None, :, :], L2)[:, :, :L]
        y = (lambda x, *d: x.permute(*d))(y, 0, 2, 1)
        return y + u * D_skip[None, None, :]

    def _B_ref(x, w1, b1, w2, b2):
        y = _layernorm(x, axis=-1)
        h = _gelu(torch.einsum("bsd,df->bsf", y, w1) + b1)
        return torch.einsum("bsf,fd->bsd", h, w2) + b2

    x = A_u
    h = x + _A_ref(_layernorm(x, axis=-1), A_log_A_real, A_A_imag, A_C_real, A_C_imag, A_log_dt, A_D_skip)
    h2 = h + _B_ref(_layernorm(h, axis=-1), B_w1, B_b1, B_w2, B_b2)
    return h2
```

```asm
; @launch kernel=k2_kernel grid=(992,1,1) block=(256,1,1) lds=42240
; @launch kernel=k3_kernel grid=(128,1,1) block=(512,1,1) lds=17408
; @launch kernel=k4_kernel grid=(240,1,1) block=(512,1,1) lds=143360
; @launch kernel=k5_kernel grid=(256,1,1) block=(512,1,1) lds=131072
.amdgcn_target "amdgcn-amd-amdhsa--gfx950"
.text
.globl k2_kernel
.p2align 8
.type k2_kernel,@function
k2_kernel:
    s_cmp_ge_u32 s2, 992
    s_cbranch_scc1 K2_END
    s_cmp_ge_u32 s2, 640
    s_cbranch_scc1 K2_TR
    s_cmp_ge_u32 s2, 512
    s_cbranch_scc1 K2_LN
    s_load_dwordx4 s[4:7], s[0:1], 8
    s_load_dwordx4 s[8:11], s[0:1], 24
    s_load_dwordx4 s[36:39], s[0:1], 40
    s_load_dwordx4 s[12:15], s[0:1], 104
    s_mov_b32 s50, 0x3fb8aa3b
    s_mov_b32 s51, 0x32a57060
    s_mov_b32 s52, 0x3f317218
    s_mov_b32 s53, 0x3e22f983
    v_and_b32 v1, 127, v0
    v_lshlrev_b32 v1, 1, v1
    s_lshl_b32 s3, s2, 8
    v_add_u32 v1, s3, v1
    s_lshl_b32 s3, s2, 1
    v_mov_b32 v7, s3
    v_lshrrev_b32 v150, 1, v0
    v_lshlrev_b32 v150, 14, v150
    v_and_b32 v3, 1, v0
    v_lshl_add_u32 v150, v3, 4, v150
    s_lshl_b32 s3, s2, 5
    v_add_u32 v150, s3, v150
    s_waitcnt lgkmcnt(0)
    s_mov_b32 s32, s36
    s_mov_b32 s33, s37
    s_mov_b32 s34, 0x400
    s_mov_b32 s35, 0x00020000
    buffer_load_ushort v6, v7, s[32:35], 0 offen
    s_mov_b32 s16, s4
    s_mov_b32 s17, s5
    s_mov_b32 s18, 0x20000
    s_mov_b32 s19, 0x00020000
    buffer_load_ushort v2, v1, s[16:19], 0 offen
    s_mov_b32 s20, s6
    s_mov_b32 s21, s7
    s_mov_b32 s22, 0x20000
    s_mov_b32 s23, 0x00020000
    buffer_load_ushort v3, v1, s[20:23], 0 offen
    s_mov_b32 s24, s8
    s_mov_b32 s25, s9
    s_mov_b32 s26, 0x20000
    s_mov_b32 s27, 0x00020000
    buffer_load_ushort v4, v1, s[24:27], 0 offen
    s_mov_b32 s28, s10
    s_mov_b32 s29, s11
    s_mov_b32 s30, 0x20000
    s_mov_b32 s31, 0x00020000
    buffer_load_ushort v5, v1, s[28:31], 0 offen
    s_mov_b32 s40, s14
    s_mov_b32 s41, s15
    s_mov_b32 s42, 0x200000
    s_mov_b32 s43, 0x00020000
    s_mov_b32 s32, s38
    s_mov_b32 s33, s39
    s_mov_b32 s34, 0x400
    s_mov_b32 s35, 0x00020000
    buffer_load_ushort v152, v7, s[32:35], 0 offen
    s_add_u32 s44, s14, 0x500000
    s_addc_u32 s45, s15, 0
    s_mov_b32 s46, 0x200000
    s_mov_b32 s47, 0x00020000
    v_mov_b32 v40, 0
    v_mov_b32 v41, 0
    v_mov_b32 v42, 0
    v_mov_b32 v43, 0
    v_lshlrev_b32 v151, 4, v0
    v_cmp_gt_u32 vcc, 166, v0
    s_nop 0
    s_and_saveexec_b64 s[48:49], vcc
    ds_write_b128 v151, v[40:43]
    s_mov_b64 exec, s[48:49]
    v_and_b32 v10, 15, v0
    v_bfe_u32 v11, v0, 4, 2
    v_lshrrev_b32 v12, 6, v0
    v_lshrrev_b32 v13, 3, v10
    v_and_b32 v14, 7, v10
    v_lshl_add_u32 v20, v13, 7, v14
    v_lshrrev_b32 v13, 2, v10
    v_and_b32 v14, 3, v10
    v_lshlrev_b32 v13, 7, v13
    v_lshl_add_u32 v13, v14, 1, v13
    v_add_u32 v13, 256, v13
    v_subrev_u32 v14, 8, v10
    v_lshrrev_b32 v15, 1, v14
    v_and_b32 v14, 1, v14
    v_lshlrev_b32 v15, 7, v15
    v_lshl_add_u32 v15, v14, 2, v15
    v_add_u32 v15, 512, v15
    v_cmp_gt_u32 vcc, 8, v10
    s_nop 1
    v_cndmask_b32 v21, v15, v13, vcc
    v_lshlrev_b32 v13, 7, v10
    v_add_u32 v13, 1024, v13
    v_cmp_gt_u32 vcc, 9, v10
    s_nop 1
    v_cndmask_b32 v22, 0, v13, vcc
    v_lshlrev_b32 v23, 3, v10
    v_cvt_f32_u32 v20, v20
    v_cvt_f32_u32 v21, v21
    v_cvt_f32_u32 v22, v22
    v_cvt_f32_u32 v23, v23
    v_lshlrev_b32 v13, 3, v0
    v_sub_u32 v13, 2047, v13
    v_subrev_u32 v64, 0, v13
    v_subrev_u32 v70, 1, v13
    v_subrev_u32 v76, 2, v13
    v_subrev_u32 v82, 3, v13
    v_subrev_u32 v88, 4, v13
    v_subrev_u32 v94, 5, v13
    v_subrev_u32 v100, 6, v13
    v_subrev_u32 v106, 7, v13
    v_cvt_f32_u32 v64, v64
    v_cvt_f32_u32 v70, v70
    v_cvt_f32_u32 v76, v76
    v_cvt_f32_u32 v82, v82
    v_cvt_f32_u32 v88, v88
    v_cvt_f32_u32 v94, v94
    v_cvt_f32_u32 v100, v100
    v_cvt_f32_u32 v106, v106
    v_cvt_pk_bf16_f32 v64, v64, v64
    v_cvt_pk_bf16_f32 v70, v70, v70
    v_cvt_pk_bf16_f32 v76, v76, v76
    v_cvt_pk_bf16_f32 v82, v82, v82
    v_cvt_pk_bf16_f32 v88, v88, v88
    v_cvt_pk_bf16_f32 v94, v94, v94
    v_cvt_pk_bf16_f32 v100, v100, v100
    v_cvt_pk_bf16_f32 v106, v106, v106
    v_lshlrev_b32 v64, 16, v64
    v_lshlrev_b32 v70, 16, v70
    v_lshlrev_b32 v76, 16, v76
    v_lshlrev_b32 v82, 16, v82
    v_lshlrev_b32 v88, 16, v88
    v_lshlrev_b32 v94, 16, v94
    v_lshlrev_b32 v100, 16, v100
    v_lshlrev_b32 v106, 16, v106
    v_cvt_u32_f32 v64, v64
    v_cvt_u32_f32 v70, v70
    v_cvt_u32_f32 v76, v76
    v_cvt_u32_f32 v82, v82
    v_cvt_u32_f32 v88, v88
    v_cvt_u32_f32 v94, v94
    v_cvt_u32_f32 v100, v100
    v_cvt_u32_f32 v106, v106
    v_lshrrev_b32 v65, 7, v64
    v_lshrrev_b32 v71, 7, v70
    v_lshrrev_b32 v77, 7, v76
    v_lshrrev_b32 v83, 7, v82
    v_lshrrev_b32 v89, 7, v88
    v_lshrrev_b32 v95, 7, v94
    v_lshrrev_b32 v101, 7, v100
    v_lshrrev_b32 v107, 7, v106
    v_and_b32 v66, 7, v64
    v_and_b32 v72, 7, v70
    v_and_b32 v78, 7, v76
    v_and_b32 v84, 7, v82
    v_and_b32 v90, 7, v88
    v_and_b32 v96, 7, v94
    v_and_b32 v102, 7, v100
    v_and_b32 v108, 7, v106
    v_bfe_u32 v67, v64, 3, 4
    v_bfe_u32 v73, v70, 3, 4
    v_bfe_u32 v79, v76, 3, 4
    v_bfe_u32 v85, v82, 3, 4
    v_bfe_u32 v91, v88, 3, 4
    v_bfe_u32 v97, v94, 3, 4
    v_bfe_u32 v103, v100, 3, 4
    v_bfe_u32 v109, v106, 3, 4
    v_lshl_add_u32 v68, v65, 3, v66
    v_lshl_add_u32 v74, v71, 3, v72
    v_lshl_add_u32 v80, v77, 3, v78
    v_lshl_add_u32 v86, v83, 3, v84
    v_lshl_add_u32 v92, v89, 3, v90
    v_lshl_add_u32 v98, v95, 3, v96
    v_lshl_add_u32 v104, v101, 3, v102
    v_lshl_add_u32 v110, v107, 3, v108
    v_lshrrev_b32 v69, 1, v66
    v_lshrrev_b32 v75, 1, v72
    v_lshrrev_b32 v81, 1, v78
    v_lshrrev_b32 v87, 1, v84
    v_lshrrev_b32 v93, 1, v90
    v_lshrrev_b32 v99, 1, v96
    v_lshrrev_b32 v105, 1, v102
    v_lshrrev_b32 v111, 1, v108
    v_lshl_add_u32 v69, v65, 2, v69
    v_lshl_add_u32 v75, v71, 2, v75
    v_lshl_add_u32 v81, v77, 2, v81
    v_lshl_add_u32 v87, v83, 2, v87
    v_lshl_add_u32 v93, v89, 2, v93
    v_lshl_add_u32 v99, v95, 2, v99
    v_lshl_add_u32 v105, v101, 2, v105
    v_lshl_add_u32 v111, v107, 2, v111
    v_add_u32 v69, 8, v69
    v_add_u32 v75, 8, v75
    v_add_u32 v81, 8, v81
    v_add_u32 v87, 8, v87
    v_add_u32 v93, 8, v93
    v_add_u32 v99, 8, v99
    v_add_u32 v105, 8, v105
    v_add_u32 v111, 8, v111
    v_cmp_gt_u32 s[54:55], 2, v65
    v_cmp_gt_u32 s[56:57], 2, v71
    v_cmp_gt_u32 s[58:59], 2, v77
    v_cmp_gt_u32 s[60:61], 2, v83
    v_cmp_gt_u32 s[62:63], 2, v89
    v_cmp_gt_u32 s[64:65], 2, v95
    v_cmp_gt_u32 s[66:67], 2, v101
    v_cmp_gt_u32 s[68:69], 2, v107
    v_cndmask_b32 v68, v69, v68, s[54:55]
    v_cndmask_b32 v74, v75, v74, s[56:57]
    v_cndmask_b32 v80, v81, v80, s[58:59]
    v_cndmask_b32 v86, v87, v86, s[60:61]
    v_cndmask_b32 v92, v93, v92, s[62:63]
    v_cndmask_b32 v98, v99, v98, s[64:65]
    v_cndmask_b32 v104, v105, v104, s[66:67]
    v_cndmask_b32 v110, v111, v110, s[68:69]
    v_lshrrev_b32 v69, 2, v66
    v_lshrrev_b32 v75, 2, v72
    v_lshrrev_b32 v81, 2, v78
    v_lshrrev_b32 v87, 2, v84
    v_lshrrev_b32 v93, 2, v90
    v_lshrrev_b32 v99, 2, v96
    v_lshrrev_b32 v105, 2, v102
    v_lshrrev_b32 v111, 2, v108
    v_lshl_add_u32 v69, v65, 1, v69
    v_lshl_add_u32 v75, v71, 1, v75
    v_lshl_add_u32 v81, v77, 1, v81
    v_lshl_add_u32 v87, v83, 1, v87
    v_lshl_add_u32 v93, v89, 1, v93
    v_lshl_add_u32 v99, v95, 1, v99
    v_lshl_add_u32 v105, v101, 1, v105
    v_lshl_add_u32 v111, v107, 1, v111
    v_add_u32 v69, 16, v69
    v_add_u32 v75, 16, v75
    v_add_u32 v81, 16, v81
    v_add_u32 v87, 16, v87
    v_add_u32 v93, 16, v93
    v_add_u32 v99, 16, v99
    v_add_u32 v105, 16, v105
    v_add_u32 v111, 16, v111
    v_cmp_gt_u32 s[54:55], 4, v65
    v_cmp_gt_u32 s[56:57], 4, v71
    v_cmp_gt_u32 s[58:59], 4, v77
    v_cmp_gt_u32 s[60:61], 4, v83
    v_cmp_gt_u32 s[62:63], 4, v89
    v_cmp_gt_u32 s[64:65], 4, v95
    v_cmp_gt_u32 s[66:67], 4, v101
    v_cmp_gt_u32 s[68:69], 4, v107
    v_cndmask_b32 v68, v69, v68, s[54:55]
    v_cndmask_b32 v74, v75, v74, s[56:57]
    v_cndmask_b32 v80, v81, v80, s[58:59]
    v_cndmask_b32 v86, v87, v86, s[60:61]
    v_cndmask_b32 v92, v93, v92, s[62:63]
    v_cndmask_b32 v98, v99, v98, s[64:65]
    v_cndmask_b32 v104, v105, v104, s[66:67]
    v_cndmask_b32 v110, v111, v110, s[68:69]
    v_add_u32 v69, 24, v65
    v_add_u32 v75, 24, v71
    v_add_u32 v81, 24, v77
    v_add_u32 v87, 24, v83
    v_add_u32 v93, 24, v89
    v_add_u32 v99, 24, v95
    v_add_u32 v105, 24, v101
    v_add_u32 v111, 24, v107
    v_cmp_gt_u32 s[54:55], 8, v65
    v_cmp_gt_u32 s[56:57], 8, v71
    v_cmp_gt_u32 s[58:59], 8, v77
    v_cmp_gt_u32 s[60:61], 8, v83
    v_cmp_gt_u32 s[62:63], 8, v89
    v_cmp_gt_u32 s[64:65], 8, v95
    v_cmp_gt_u32 s[66:67], 8, v101
    v_cmp_gt_u32 s[68:69], 8, v107
    v_cndmask_b32 v68, v69, v68, s[54:55]
    v_cndmask_b32 v74, v75, v74, s[56:57]
    v_cndmask_b32 v80, v81, v80, s[58:59]
    v_cndmask_b32 v86, v87, v86, s[60:61]
    v_cndmask_b32 v92, v93, v92, s[62:63]
    v_cndmask_b32 v98, v99, v98, s[64:65]
    v_cndmask_b32 v104, v105, v104, s[66:67]
    v_cndmask_b32 v110, v111, v110, s[68:69]
    v_lshl_add_u32 v68, v68, 4, v67
    v_lshl_add_u32 v74, v74, 4, v73
    v_lshl_add_u32 v80, v80, 4, v79
    v_lshl_add_u32 v86, v86, 4, v85
    v_lshl_add_u32 v92, v92, 4, v91
    v_lshl_add_u32 v98, v98, 4, v97
    v_lshl_add_u32 v104, v104, 4, v103
    v_lshl_add_u32 v110, v110, 4, v109
    v_lshlrev_b32 v112, 2, v68
    v_lshlrev_b32 v113, 2, v74
    v_lshlrev_b32 v114, 2, v80
    v_lshlrev_b32 v115, 2, v86
    v_lshlrev_b32 v116, 2, v92
    v_lshlrev_b32 v117, 2, v98
    v_lshlrev_b32 v118, 2, v104
    v_lshlrev_b32 v119, 2, v110
    s_waitcnt vmcnt(1)
    v_lshlrev_b32 v2, 16, v2
    v_lshlrev_b32 v3, 16, v3
    v_lshlrev_b32 v4, 16, v4
    v_lshlrev_b32 v5, 16, v5
    v_lshlrev_b32 v6, 16, v6
    v_mul_f32 v13, s50, v6
    v_fma_f32 v14, v6, s50, -v13
    v_fma_f32 v14, v6, s51, v14
    v_exp_f32 v8, v13
    v_mul_f32 v14, s52, v14
    v_fma_f32 v8, v8, v14, v8
    v_mul_f32 v15, s50, v2
    v_fma_f32 v16, v2, s50, -v15
    v_fma_f32 v16, v2, s51, v16
    v_exp_f32 v9, v15
    v_mul_f32 v16, s52, v16
    v_fma_f32 v9, v9, v16, v9
    v_cvt_pk_bf16_f32 v13, v8, v9
    v_lshlrev_b32 v8, 16, v13
    v_and_b32 v9, 0xffff0000, v13
    v_mul_f32 v24, -v9, v8
    v_mul_f32 v25, v3, v8
    v_mul_f32 v26, v4, v8
    v_mul_f32 v27, v5, v8
    v_mul_f32 v24, s50, v24
    v_mul_f32 v25, s53, v25
    v_add_f32 v26, v26, v26
    v_add_f32 v27, v27, v27
    v_and_b32 v13, 127, v0
    v_lshlrev_b32 v13, 4, v13
    ds_write_b128 v13, v[24:27] offset:25088
    v_add_f32 v14, abs(v26), abs(v27)
    s_nop 1
    v_add_f32_dpp v14, v14, v14 row_ror:8 row_mask:0xf bank_mask:0xf
    s_nop 1
    v_add_f32_dpp v14, v14, v14 row_ror:4 row_mask:0xf bank_mask:0xf
    s_nop 1
    v_add_f32_dpp v14, v14, v14 row_ror:2 row_mask:0xf bank_mask:0xf
    s_nop 1
    v_add_f32_dpp v14, v14, v14 row_ror:1 row_mask:0xf bank_mask:0xf
    v_mov_b32 v15, v14
    s_nop 1
    v_permlane16_swap_b32 v14, v15
    v_add_f32 v14, v14, v15
    v_mov_b32 v15, v14
    s_nop 1
    v_permlane32_swap_b32 v14, v15
    v_add_f32 v14, v14, v15
    v_lshlrev_b32 v16, 2, v12
    ds_write_b32 v16, v14 offset:0
    s_waitcnt lgkmcnt(0)
    s_barrier
    v_mov_b32 v16, 0
    ds_read_b64 v[148:149], v16 offset:0
    v_lshlrev_b32 v13, 5, v12
    v_add_u32 v13, v13, v11
    v_lshlrev_b32 v13, 4, v13
    ds_read_b128 v[64:67], v13 offset:25088
    ds_read_b128 v[68:71], v13 offset:25152
    ds_read_b128 v[72:75], v13 offset:25216
    ds_read_b128 v[76:79], v13 offset:25280
    ds_read_b128 v[80:83], v13 offset:25344
    ds_read_b128 v[84:87], v13 offset:25408
    ds_read_b128 v[88:91], v13 offset:25472
    ds_read_b128 v[92:95], v13 offset:25536
    v_mov_b32 v100, 0
    v_mov_b32 v101, 0
    v_mov_b32 v102, 0
    v_mov_b32 v103, 0
    v_mov_b32 v104, 0
    v_mov_b32 v105, 0
    v_mov_b32 v106, 0
    v_mov_b32 v107, 0
    v_mov_b32 v108, 0
    v_mov_b32 v109, 0
    v_mov_b32 v110, 0
    v_mov_b32 v111, 0
    s_waitcnt lgkmcnt(0)
    v_add_f32 v148, v148, v149
    v_frexp_exp_i32_f32 v15, v148
    v_mov_b32 v16, -100
    v_mov_b32 v17, 100
    v_med3_i32 v15, v15, v16, v17
    v_sub_u32 v153, 15, v15
    v_subrev_u32 v15, 15, v15
    v_ldexp_f32 v148, 1.0, v15
    v_mul_f32 v32, v64, v23
    v_mul_f32 v34, v64, v20
    v_mul_f32 v38, v64, v21
    v_mul_f32 v42, v64, v22
    v_mul_f32 v33, v65, v23
    v_mul_f32 v35, v65, v20
    v_mul_f32 v39, v65, v21
    v_mul_f32 v43, v65, v22
    v_exp_f32 v32, v32
    v_exp_f32 v34, v34
    v_exp_f32 v38, v38
    v_exp_f32 v42, v42
    v_fract_f32 v33, v33
    v_fract_f32 v35, v35
    v_fract_f32 v39, v39
    v_fract_f32 v43, v43
    v_cos_f32 v28, v33
    v_cos_f32 v36, v35
    v_cos_f32 v40, v39
    v_cos_f32 v44, v43
    v_sin_f32 v29, v33
    v_sin_f32 v37, v35
    v_sin_f32 v41, v39
    v_sin_f32 v45, v43
    v_mul_f32 v28, v32, v28
    v_mul_f32 v36, v34, v36
    v_mul_f32 v40, v38, v40
    v_mul_f32 v44, v42, v44
    v_mul_f32 v29, v32, v29
    v_mul_f32 v37, v34, v37
    v_mul_f32 v41, v38, v41
    v_mul_f32 v45, v42, v45
    v_mul_f32 v46, v66, v36
    v_mul_f32 v48, v66, v40
    v_mul_f32 v50, v66, v44
    v_mul_f32 v47, -v66, v37
    v_mul_f32 v49, -v66, v41
    v_mul_f32 v51, -v66, v45
    v_fma_f32 v46, -v67, v37, v46
    v_fma_f32 v48, -v67, v41, v48
    v_fma_f32 v50, -v67, v45, v50
    v_fma_f32 v47, -v67, v36, v47
    v_fma_f32 v49, -v67, v40, v49
    v_fma_f32 v51, -v67, v44, v51
    v_mfma_f32_16x16x4_f32 v[100:103], v46, v28, v[100:103]
    v_mfma_f32_16x16x4_f32 v[104:107], v48, v28, v[104:107]
    v_mfma_f32_16x16x4_f32 v[108:111], v50, v28, v[108:111]
    v_mfma_f32_16x16x4_f32 v[100:103], v47, v29, v[100:103]
    v_mfma_f32_16x16x4_f32 v[104:107], v49, v29, v[104:107]
    v_mfma_f32_16x16x4_f32 v[108:111], v51, v29, v[108:111]
    v_mul_f32 v32, v68, v23
    v_mul_f32 v34, v68, v20
    v_mul_f32 v38, v68, v21
    v_mul_f32 v42, v68, v22
    v_mul_f32 v33, v69, v23
    v_mul_f32 v35, v69, v20
    v_mul_f32 v39, v69, v21
    v_mul_f32 v43, v69, v22
    v_exp_f32 v32, v32
    v_exp_f32 v34, v34
    v_exp_f32 v38, v38
    v_exp_f32 v42, v42
    v_fract_f32 v33, v33
    v_fract_f32 v35, v35
    v_fract_f32 v39, v39
    v_fract_f32 v43, v43
    v_cos_f32 v30, v33
    v_cos_f32 v36, v35
    v_cos_f32 v40, v39
    v_cos_f32 v44, v43
    v_sin_f32 v31, v33
    v_sin_f32 v37, v35
    v_sin_f32 v41, v39
    v_sin_f32 v45, v43
    v_mul_f32 v30, v32, v30
    v_mul_f32 v36, v34, v36
    v_mul_f32 v40, v38, v40
    v_mul_f32 v44, v42, v44
    v_mul_f32 v31, v32, v31
    v_mul_f32 v37, v34, v37
    v_mul_f32 v41, v38, v41
    v_mul_f32 v45, v42, v45
    v_mul_f32 v52, v70, v36
    v_mul_f32 v54, v70, v40
    v_mul_f32 v56, v70, v44
    v_mul_f32 v53, -v70, v37
    v_mul_f32 v55, -v70, v41
    v_mul_f32 v57, -v70, v45
    v_fma_f32 v52, -v71, v37, v52
    v_fma_f32 v54, -v71, v41, v54
    v_fma_f32 v56, -v71, v45, v56
    v_fma_f32 v53, -v71, v36, v53
    v_fma_f32 v55, -v71, v40, v55
    v_fma_f32 v57, -v71, v44, v57
    v_mfma_f32_16x16x4_f32 v[100:103], v52, v30, v[100:103]
    v_mfma_f32_16x16x4_f32 v[104:107], v54, v30, v[104:107]
    v_mfma_f32_16x16x4_f32 v[108:111], v56, v30, v[108:111]
    v_mfma_f32_16x16x4_f32 v[100:103], v53, v31, v[100:103]
    v_mfma_f32_16x16x4_f32 v[104:107], v55, v31, v[104:107]
    v_mfma_f32_16x16x4_f32 v[108:111], v57, v31, v[108:111]
    v_mul_f32 v32, v72, v23
    v_mul_f32 v34, v72, v20
    v_mul_f32 v38, v72, v21
    v_mul_f32 v42, v72, v22
    v_mul_f32 v33, v73, v23
    v_mul_f32 v35, v73, v20
    v_mul_f32 v39, v73, v21
    v_mul_f32 v43, v73, v22
    v_exp_f32 v32, v32
    v_exp_f32 v34, v34
    v_exp_f32 v38, v38
    v_exp_f32 v42, v42
    v_fract_f32 v33, v33
    v_fract_f32 v35, v35
    v_fract_f32 v39, v39
    v_fract_f32 v43, v43
    v_cos_f32 v28, v33
    v_cos_f32 v36, v35
    v_cos_f32 v40, v39
    v_cos_f32 v44, v43
    v_sin_f32 v29, v33
    v_sin_f32 v37, v35
    v_sin_f32 v41, v39
    v_sin_f32 v45, v43
    v_mul_f32 v28, v32, v28
    v_mul_f32 v36, v34, v36
    v_mul_f32 v40, v38, v40
    v_mul_f32 v44, v42, v44
    v_mul_f32 v29, v32, v29
    v_mul_f32 v37, v34, v37
    v_mul_f32 v41, v38, v41
    v_mul_f32 v45, v42, v45
    v_mul_f32 v46, v74, v36
    v_mul_f32 v48, v74, v40
    v_mul_f32 v50, v74, v44
    v_mul_f32 v47, -v74, v37
    v_mul_f32 v49, -v74, v41
    v_mul_f32 v51, -v74, v45
    v_fma_f32 v46, -v75, v37, v46
    v_fma_f32 v48, -v75, v41, v48
    v_fma_f32 v50, -v75, v45, v50
    v_fma_f32 v47, -v75, v36, v47
    v_fma_f32 v49, -v75, v40, v49
    v_fma_f32 v51, -v75, v44, v51
    v_mfma_f32_16x16x4_f32 v[100:103], v46, v28, v[100:103]
    v_mfma_f32_16x16x4_f32 v[104:107], v48, v28, v[104:107]
    v_mfma_f32_16x16x4_f32 v[108:111], v50, v28, v[108:111]
    v_mfma_f32_16x16x4_f32 v[100:103], v47, v29, v[100:103]
    v_mfma_f32_16x16x4_f32 v[104:107], v49, v29, v[104:107]
    v_mfma_f32_16x16x4_f32 v[108:111], v51, v29, v[108:111]
    v_mul_f32 v32, v76, v23
    v_mul_f32 v34, v76, v20
    v_mul_f32 v38, v76, v21
    v_mul_f32 v42, v76, v22
    v_mul_f32 v33, v77, v23
    v_mul_f32 v35, v77, v20
    v_mul_f32 v39, v77, v21
    v_mul_f32 v43, v77, v22
    v_exp_f32 v32, v32
    v_exp_f32 v34, v34
    v_exp_f32 v38, v38
    v_exp_f32 v42, v42
    v_fract_f32 v33, v33
    v_fract_f32 v35, v35
    v_fract_f32 v39, v39
    v_fract_f32 v43, v43
    v_cos_f32 v30, v33
    v_cos_f32 v36, v35
    v_cos_f32 v40, v39
    v_cos_f32 v44, v43
    v_sin_f32 v31, v33
    v_sin_f32 v37, v35
    v_sin_f32 v41, v39
    v_sin_f32 v45, v43
    v_mul_f32 v30, v32, v30
    v_mul_f32 v36, v34, v36
    v_mul_f32 v40, v38, v40
    v_mul_f32 v44, v42, v44
    v_mul_f32 v31, v32, v31
    v_mul_f32 v37, v34, v37
    v_mul_f32 v41, v38, v41
    v_mul_f32 v45, v42, v45
    v_mul_f32 v52, v78, v36
    v_mul_f32 v54, v78, v40
    v_mul_f32 v56, v78, v44
    v_mul_f32 v53, -v78, v37
    v_mul_f32 v55, -v78, v41
    v_mul_f32 v57, -v78, v45
    v_fma_f32 v52, -v79, v37, v52
    v_fma_f32 v54, -v79, v41, v54
    v_fma_f32 v56, -v79, v45, v56
    v_fma_f32 v53, -v79, v36, v53
    v_fma_f32 v55, -v79, v40, v55
    v_fma_f32 v57, -v79, v44, v57
    v_mfma_f32_16x16x4_f32 v[100:103], v52, v30, v[100:103]
    v_mfma_f32_16x16x4_f32 v[104:107], v54, v30, v[104:107]
    v_mfma_f32_16x16x4_f32 v[108:111], v56, v30, v[108:111]
    v_mfma_f32_16x16x4_f32 v[100:103], v53, v31, v[100:103]
    v_mfma_f32_16x16x4_f32 v[104:107], v55, v31, v[104:107]
    v_mfma_f32_16x16x4_f32 v[108:111], v57, v31, v[108:111]
    v_mul_f32 v32, v80, v23
    v_mul_f32 v34, v80, v20
    v_mul_f32 v38, v80, v21
    v_mul_f32 v42, v80, v22
    v_mul_f32 v33, v81, v23
    v_mul_f32 v35, v81, v20
    v_mul_f32 v39, v81, v21
    v_mul_f32 v43, v81, v22
    v_exp_f32 v32, v32
    v_exp_f32 v34, v34
    v_exp_f32 v38, v38
    v_exp_f32 v42, v42
    v_fract_f32 v33, v33
    v_fract_f32 v35, v35
    v_fract_f32 v39, v39
    v_fract_f32 v43, v43
    v_cos_f32 v28, v33
    v_cos_f32 v36, v35
    v_cos_f32 v40, v39
    v_cos_f32 v44, v43
    v_sin_f32 v29, v33
    v_sin_f32 v37, v35
    v_sin_f32 v41, v39
    v_sin_f32 v45, v43
    v_mul_f32 v28, v32, v28
    v_mul_f32 v36, v34, v36
    v_mul_f32 v40, v38, v40
    v_mul_f32 v44, v42, v44
    v_mul_f32 v29, v32, v29
    v_mul_f32 v37, v34, v37
    v_mul_f32 v41, v38, v41
    v_mul_f32 v45, v42, v45
    v_mul_f32 v46, v82, v36
    v_mul_f32 v48, v82, v40
    v_mul_f32 v50, v82, v44
    v_mul_f32 v47, -v82, v37
    v_mul_f32 v49, -v82, v41
    v_mul_f32 v51, -v82, v45
    v_fma_f32 v46, -v83, v37, v46
    v_fma_f32 v48, -v83, v41, v48
    v_fma_f32 v50, -v83, v45, v50
    v_fma_f32 v47, -v83, v36, v47
    v_fma_f32 v49, -v83, v40, v49
    v_fma_f32 v51, -v83, v44, v51
    v_mfma_f32_16x16x4_f32 v[100:103], v46, v28, v[100:103]
    v_mfma_f32_16x16x4_f32 v[104:107], v48, v28, v[104:107]
    v_mfma_f32_16x16x4_f32 v[108:111], v50, v28, v[108:111]
    v_mfma_f32_16x16x4_f32 v[100:103], v47, v29, v[100:103]
    v_mfma_f32_16x16x4_f32 v[104:107], v49, v29, v[104:107]
    v_mfma_f32_16x16x4_f32 v[108:111], v51, v29, v[108:111]
    v_mul_f32 v32, v84, v23
    v_mul_f32 v34, v84, v20
    v_mul_f32 v38, v84, v21
    v_mul_f32 v42, v84, v22
    v_mul_f32 v33, v85, v23
    v_mul_f32 v35, v85, v20
    v_mul_f32 v39, v85, v21
    v_mul_f32 v43, v85, v22
    v_exp_f32 v32, v32
    v_exp_f32 v34, v34
    v_exp_f32 v38, v38
    v_exp_f32 v42, v42
    v_fract_f32 v33, v33
    v_fract_f32 v35, v35
    v_fract_f32 v39, v39
    v_fract_f32 v43, v43
    v_cos_f32 v30, v33
    v_cos_f32 v36, v35
    v_cos_f32 v40, v39
    v_cos_f32 v44, v43
    v_sin_f32 v31, v33
    v_sin_f32 v37, v35
    v_sin_f32 v41, v39
    v_sin_f32 v45, v43
    v_mul_f32 v30, v32, v30
    v_mul_f32 v36, v34, v36
    v_mul_f32 v40, v38, v40
    v_mul_f32 v44, v42, v44
    v_mul_f32 v31, v32, v31
    v_mul_f32 v37, v34, v37
    v_mul_f32 v41, v38, v41
    v_mul_f32 v45, v42, v45
    v_mul_f32 v52, v86, v36
    v_mul_f32 v54, v86, v40
    v_mul_f32 v56, v86, v44
    v_mul_f32 v53, -v86, v37
    v_mul_f32 v55, -v86, v41
    v_mul_f32 v57, -v86, v45
    v_fma_f32 v52, -v87, v37, v52
    v_fma_f32 v54, -v87, v41, v54
    v_fma_f32 v56, -v87, v45, v56
    v_fma_f32 v53, -v87, v36, v53
    v_fma_f32 v55, -v87, v40, v55
    v_fma_f32 v57, -v87, v44, v57
    v_mfma_f32_16x16x4_f32 v[100:103], v52, v30, v[100:103]
    v_mfma_f32_16x16x4_f32 v[104:107], v54, v30, v[104:107]
    v_mfma_f32_16x16x4_f32 v[108:111], v56, v30, v[108:111]
    v_mfma_f32_16x16x4_f32 v[100:103], v53, v31, v[100:103]
    v_mfma_f32_16x16x4_f32 v[104:107], v55, v31, v[104:107]
    v_mfma_f32_16x16x4_f32 v[108:111], v57, v31, v[108:111]
    v_mul_f32 v32, v88, v23
    v_mul_f32 v34, v88, v20
    v_mul_f32 v38, v88, v21
    v_mul_f32 v42, v88, v22
    v_mul_f32 v33, v89, v23
    v_mul_f32 v35, v89, v20
    v_mul_f32 v39, v89, v21
    v_mul_f32 v43, v89, v22
    v_exp_f32 v32, v32
    v_exp_f32 v34, v34
    v_exp_f32 v38, v38
    v_exp_f32 v42, v42
    v_fract_f32 v33, v33
    v_fract_f32 v35, v35
    v_fract_f32 v39, v39
    v_fract_f32 v43, v43
    v_cos_f32 v28, v33
    v_cos_f32 v36, v35
    v_cos_f32 v40, v39
    v_cos_f32 v44, v43
    v_sin_f32 v29, v33
    v_sin_f32 v37, v35
    v_sin_f32 v41, v39
    v_sin_f32 v45, v43
    v_mul_f32 v28, v32, v28
    v_mul_f32 v36, v34, v36
    v_mul_f32 v40, v38, v40
    v_mul_f32 v44, v42, v44
    v_mul_f32 v29, v32, v29
    v_mul_f32 v37, v34, v37
    v_mul_f32 v41, v38, v41
    v_mul_f32 v45, v42, v45
    v_mul_f32 v46, v90, v36
    v_mul_f32 v48, v90, v40
    v_mul_f32 v50, v90, v44
    v_mul_f32 v47, -v90, v37
    v_mul_f32 v49, -v90, v41
    v_mul_f32 v51, -v90, v45
    v_fma_f32 v46, -v91, v37, v46
    v_fma_f32 v48, -v91, v41, v48
    v_fma_f32 v50, -v91, v45, v50
    v_fma_f32 v47, -v91, v36, v47
    v_fma_f32 v49, -v91, v40, v49
    v_fma_f32 v51, -v91, v44, v51
    v_mfma_f32_16x16x4_f32 v[100:103], v46, v28, v[100:103]
    v_mfma_f32_16x16x4_f32 v[104:107], v48, v28, v[104:107]
    v_mfma_f32_16x16x4_f32 v[108:111], v50, v28, v[108:111]
    v_mfma_f32_16x16x4_f32 v[100:103], v47, v29, v[100:103]
    v_mfma_f32_16x16x4_f32 v[104:107], v49, v29, v[104:107]
    v_mfma_f32_16x16x4_f32 v[108:111], v51, v29, v[108:111]
    v_mul_f32 v32, v92, v23
    v_mul_f32 v34, v92, v20
    v_mul_f32 v38, v92, v21
    v_mul_f32 v42, v92, v22
    v_mul_f32 v33, v93, v23
    v_mul_f32 v35, v93, v20
    v_mul_f32 v39, v93, v21
    v_mul_f32 v43, v93, v22
    v_exp_f32 v32, v32
    v_exp_f32 v34, v34
    v_exp_f32 v38, v38
    v_exp_f32 v42, v42
    v_fract_f32 v33, v33
    v_fract_f32 v35, v35
    v_fract_f32 v39, v39
    v_fract_f32 v43, v43
    v_cos_f32 v30, v33
    v_cos_f32 v36, v35
    v_cos_f32 v40, v39
    v_cos_f32 v44, v43
    v_sin_f32 v31, v33
    v_sin_f32 v37, v35
    v_sin_f32 v41, v39
    v_sin_f32 v45, v43
    v_mul_f32 v30, v32, v30
    v_mul_f32 v36, v34, v36
    v_mul_f32 v40, v38, v40
    v_mul_f32 v44, v42, v44
    v_mul_f32 v31, v32, v31
    v_mul_f32 v37, v34, v37
    v_mul_f32 v41, v38, v41
    v_mul_f32 v45, v42, v45
    v_mul_f32 v52, v94, v36
    v_mul_f32 v54, v94, v40
    v_mul_f32 v56, v94, v44
    v_mul_f32 v53, -v94, v37
    v_mul_f32 v55, -v94, v41
    v_mul_f32 v57, -v94, v45
    v_fma_f32 v52, -v95, v37, v52
    v_fma_f32 v54, -v95, v41, v54
    v_fma_f32 v56, -v95, v45, v56
    v_fma_f32 v53, -v95, v36, v53
    v_fma_f32 v55, -v95, v40, v55
    v_fma_f32 v57, -v95, v44, v57
    v_mfma_f32_16x16x4_f32 v[100:103], v52, v30, v[100:103]
    v_mfma_f32_16x16x4_f32 v[104:107], v54, v30, v[104:107]
    v_mfma_f32_16x16x4_f32 v[108:111], v56, v30, v[108:111]
    v_mfma_f32_16x16x4_f32 v[100:103], v53, v31, v[100:103]
    v_mfma_f32_16x16x4_f32 v[104:107], v55, v31, v[104:107]
    v_mfma_f32_16x16x4_f32 v[108:111], v57, v31, v[108:111]
    v_mul_u32_u24 v13, 3072, v12
    v_lshl_add_u32 v13, v11, 8, v13
    v_lshl_add_u32 v13, v10, 2, v13
    s_nop 4
    ds_write_b32 v13, v100 offset:27136
    ds_write_b32 v13, v101 offset:27200
    ds_write_b32 v13, v102 offset:27264
    ds_write_b32 v13, v103 offset:27328
    ds_write_b32 v13, v104 offset:28160
    ds_write_b32 v13, v105 offset:28224
    ds_write_b32 v13, v106 offset:28288
    ds_write_b32 v13, v107 offset:28352
    ds_write_b32 v13, v108 offset:29184
    ds_write_b32 v13, v109 offset:29248
    ds_write_b32 v13, v110 offset:29312
    ds_write_b32 v13, v111 offset:29376
    v_and_b32 v7, 7, v0
    s_waitcnt lgkmcnt(0)
    s_barrier
    ds_read_b32 v72, v112 offset:27136
    ds_read_b32 v73, v112 offset:30208
    ds_read_b32 v74, v112 offset:33280
    ds_read_b32 v75, v112 offset:36352
    ds_read_b32 v76, v113 offset:27136
    ds_read_b32 v77, v113 offset:30208
    ds_read_b32 v78, v113 offset:33280
    ds_read_b32 v79, v113 offset:36352
    ds_read_b32 v80, v114 offset:27136
    ds_read_b32 v81, v114 offset:30208
    ds_read_b32 v82, v114 offset:33280
    ds_read_b32 v83, v114 offset:36352
    ds_read_b32 v84, v115 offset:27136
    ds_read_b32 v85, v115 offset:30208
    ds_read_b32 v86, v115 offset:33280
    ds_read_b32 v87, v115 offset:36352
    ds_read_b32 v88, v116 offset:27136
    ds_read_b32 v89, v116 offset:30208
    ds_read_b32 v90, v116 offset:33280
    ds_read_b32 v91, v116 offset:36352
    ds_read_b32 v92, v117 offset:27136
    ds_read_b32 v93, v117 offset:30208
    ds_read_b32 v94, v117 offset:33280
    ds_read_b32 v95, v117 offset:36352
    ds_read_b32 v96, v118 offset:27136
    ds_read_b32 v97, v118 offset:30208
    ds_read_b32 v98, v118 offset:33280
    ds_read_b32 v99, v118 offset:36352
    ds_read_b32 v100, v119 offset:27136
    ds_read_b32 v101, v119 offset:30208
    ds_read_b32 v102, v119 offset:33280
    ds_read_b32 v103, v119 offset:36352
    s_waitcnt lgkmcnt(0)
    v_add_f32 v72, v72, v73
    v_add_f32 v74, v74, v75
    v_add_f32 v76, v76, v77
    v_add_f32 v78, v78, v79
    v_add_f32 v80, v80, v81
    v_add_f32 v82, v82, v83
    v_add_f32 v84, v84, v85
    v_add_f32 v86, v86, v87
    v_add_f32 v88, v88, v89
    v_add_f32 v90, v90, v91
    v_add_f32 v92, v92, v93
    v_add_f32 v94, v94, v95
    v_add_f32 v96, v96, v97
    v_add_f32 v98, v98, v99
    v_add_f32 v100, v100, v101
    v_add_f32 v102, v102, v103
    v_add_f32 v64, v72, v74
    v_add_f32 v65, v76, v78
    v_add_f32 v66, v80, v82
    v_add_f32 v67, v84, v86
    v_add_f32 v68, v88, v90
    v_add_f32 v69, v92, v94
    v_add_f32 v70, v96, v98
    v_add_f32 v71, v100, v102
    v_ldexp_f32 v64, v64, v153
    v_ldexp_f32 v65, v65, v153
    v_ldexp_f32 v66, v66, v153
    v_ldexp_f32 v67, v67, v153
    v_ldexp_f32 v68, v68, v153
    v_ldexp_f32 v69, v69, v153
    v_ldexp_f32 v70, v70, v153
    v_ldexp_f32 v71, v71, v153
    v_cvt_f16_f32 v64, v64
    v_cvt_f16_f32 v65, v65
    v_cvt_f16_f32 v66, v66
    v_cvt_f16_f32 v67, v67
    v_cvt_f16_f32 v68, v68
    v_cvt_f16_f32 v69, v69
    v_cvt_f16_f32 v70, v70
    v_cvt_f16_f32 v71, v71
    v_pack_b32_f16 v16, v64, v65
    v_pack_b32_f16 v17, v66, v67
    v_pack_b32_f16 v18, v68, v69
    v_pack_b32_f16 v19, v70, v71
    ds_write_b128 v151, v[16:19] offset:7936
    v_mov_b32 v40, 0
    v_mov_b32 v41, 0
    v_mov_b32 v42, 0
    v_mov_b32 v43, 0
    v_lshrrev_b32 v6, 3, v0
    v_mul_u32_u24 v6, 4288, v6
    v_lshl_add_u32 v6, v7, 4, v6
    v_cmp_gt_u32 vcc, 8, v0
    s_nop 0
    s_and_saveexec_b64 s[48:49], vcc
    ds_write_b128 v6, v[40:43] offset:12032
    s_mov_b64 exec, s[48:49]
    v_readfirstlane_b32 s58, v12
    s_nop 0
    s_cmp_lg_u32 s58, 0
    s_cbranch_scc1 K2_NOPOLL
    s_mov_b32 s60, s12
    s_mov_b32 s61, s13
    s_mov_b32 s62, 0x100
    s_mov_b32 s63, 0x00020000
    v_mov_b32 v58, 0
K2_POLL:
    buffer_load_dword v59, v58, s[60:63], 0 offen sc1
    s_waitcnt vmcnt(0)
    v_readfirstlane_b32 s58, v59
    s_nop 0
    s_cmp_ge_u32 s58, 128
    s_cbranch_scc1 K2_POLLED
    s_sleep 16
    s_branch K2_POLL
K2_POLLED:
K2_NOPOLL:
    s_waitcnt lgkmcnt(0)
    s_barrier
    buffer_load_dwordx4 v[144:147], v150, s[40:43], 0 offen sc1
    ds_read_b128 v[20:23], v151 offset:7952
    v_mov_b32 v8, v10
    v_mov_b32 v9, v11
    v_mov_b32 v10, v12
    v_readfirstlane_b32 s42, v12
    s_waitcnt lgkmcnt(0)
    v_alignbit_b32 v32, v17, v16, 16
    v_alignbit_b32 v33, v18, v17, 16
    v_alignbit_b32 v34, v19, v18, 16
    v_alignbit_b32 v35, v20, v19, 16
    v_alignbit_b32 v36, v21, v20, 16
    v_alignbit_b32 v37, v22, v21, 16
    v_alignbit_b32 v38, v23, v22, 16
    v_mov_b32 v48, v17
    v_mov_b32 v52, v19
    v_mov_b32 v56, v33
    v_mov_b32 v60, v35
    v_mov_b32 v49, v18
    v_mov_b32 v53, v20
    v_mov_b32 v57, v34
    v_mov_b32 v61, v36
    v_mov_b32 v50, v19
    v_mov_b32 v54, v21
    v_mov_b32 v58, v35
    v_mov_b32 v62, v37
    v_mov_b32 v51, v20
    v_mov_b32 v55, v22
    v_mov_b32 v59, v36
    v_mov_b32 v63, v38
    ds_write_b128 v151, v[32:35] offset:12224
    ds_write_b128 v151, v[48:51] offset:16512
    ds_write_b128 v151, v[56:59] offset:20800
    ds_write_b128 v151, v[18:21] offset:25088
    ds_write_b128 v151, v[34:37] offset:29376
    ds_write_b128 v151, v[52:55] offset:33664
    ds_write_b128 v151, v[60:63] offset:37952
    v_cmp_gt_u32 vcc, 64, v0
    s_nop 0
    s_and_saveexec_b64 s[48:49], vcc
    ds_write_b128 v6, v[40:43] offset:12032
    s_mov_b64 exec, s[48:49]
    s_mul_i32 s43, s42, 6
    s_cmp_eq_u32 s42, 3
    s_cselect_b32 s56, 2, 0
    s_add_u32 s43, s43, s56
    s_cmp_lt_u32 s42, 2
    s_cselect_b32 s54, 3, 2
    s_cmp_eq_u32 s42, 3
    s_cselect_b32 s54, 0, s54
    s_cmp_lt_u32 s42, 2
    s_cselect_b32 s55, 0, 2
    s_cmp_eq_u32 s42, 3
    s_cselect_b32 s55, 6, s55
    v_and_b32 v13, 7, v8
    v_sub_u32 v13, 7, v13
    v_mul_u32_u24 v11, 4288, v13
    v_lshrrev_b32 v13, 3, v8
    v_sub_u32 v13, v9, v13
    v_lshl_add_u32 v11, v13, 4, v11
    s_lshl_b32 s57, s43, 7
    s_sub_u32 s57, 11920, s57
    v_add_u32 v11, s57, v11
    v_mul_u32_u24 v12, 160, v8
    v_lshl_add_u32 v12, v9, 4, v12
    s_mul_i32 s57, s43, 160
    s_sub_u32 s57, 2656, s57
    v_add_u32 v12, s57, v12
    v_mov_b32 v112, 0
    v_mov_b32 v113, 0
    v_mov_b32 v114, 0
    v_mov_b32 v115, 0
    v_mov_b32 v116, 0
    v_mov_b32 v117, 0
    v_mov_b32 v118, 0
    v_mov_b32 v119, 0
    v_mov_b32 v120, 0
    v_mov_b32 v121, 0
    v_mov_b32 v122, 0
    v_mov_b32 v123, 0
    v_mov_b32 v124, 0
    v_mov_b32 v125, 0
    v_mov_b32 v126, 0
    v_mov_b32 v127, 0
    v_mov_b32 v128, 0
    v_mov_b32 v129, 0
    v_mov_b32 v130, 0
    v_mov_b32 v131, 0
    v_mov_b32 v132, 0
    v_mov_b32 v133, 0
    v_mov_b32 v134, 0
    v_mov_b32 v135, 0
    v_mov_b32 v136, 0
    v_mov_b32 v137, 0
    v_mov_b32 v138, 0
    v_mov_b32 v139, 0
    v_mov_b32 v140, 0
    v_mov_b32 v141, 0
    v_mov_b32 v142, 0
    v_mov_b32 v143, 0
    s_waitcnt vmcnt(0)
    v_lshlrev_b32 v58, 16, v144
    v_and_b32 v59, 0xffff0000, v144
    v_cvt_pkrtz_f16_f32 v64, v58, v59
    v_lshlrev_b32 v58, 16, v145
    v_and_b32 v59, 0xffff0000, v145
    v_cvt_pkrtz_f16_f32 v65, v58, v59
    v_lshlrev_b32 v58, 16, v146
    v_and_b32 v59, 0xffff0000, v146
    v_cvt_pkrtz_f16_f32 v66, v58, v59
    v_lshlrev_b32 v58, 16, v147
    v_and_b32 v59, 0xffff0000, v147
    v_cvt_pkrtz_f16_f32 v67, v58, v59
    v_lshrrev_b32 v58, 3, v0
    v_mul_u32_u24 v58, 160, v58
    v_lshl_add_u32 v58, v7, 4, v58
    ds_write_b128 v58, v[64:67] offset:2656
    s_waitcnt lgkmcnt(0)
    s_barrier
    ds_read_b128 v[88:91], v11 offset:160
    ds_read_b128 v[92:95], v11 offset:128
    ds_read_b128 v[48:51], v11 offset:96
    ds_read_b128 v[52:55], v11 offset:64
    ds_read_b128 v[56:59], v11 offset:32
    ds_read_b128 v[60:63], v11 offset:0
    ds_read_b128 v[64:67], v12 offset:0
    ds_read_b128 v[68:71], v12 offset:64
    ds_read_b128 v[72:75], v12 offset:2560
    ds_read_b128 v[76:79], v12 offset:2624
    s_cmp_eq_u32 s54, 0
    s_cbranch_scc1 K2_L1PRE
K2_L2:
    s_waitcnt lgkmcnt(0)
    v_mfma_f32_16x16x32_f16 v[112:115], v[88:91], v[68:71], v[112:115]
    v_mfma_f32_16x16x32_f16 v[116:119], v[92:95], v[68:71], v[116:119]
    v_mfma_f32_16x16x32_f16 v[128:131], v[88:91], v[76:79], v[128:131]
    v_mfma_f32_16x16x32_f16 v[132:135], v[92:95], v[76:79], v[132:135]
    v_subrev_u32 v11, 128, v11
    v_subrev_u32 v12, 160, v12
    ds_read_b128 v[80:83], v11 offset:96
    ds_read_b128 v[84:87], v11 offset:64
    ds_read_b128 v[88:91], v11 offset:32
    ds_read_b128 v[92:95], v11 offset:0
    ds_read_b128 v[96:99], v12 offset:0
    ds_read_b128 v[100:103], v12 offset:64
    ds_read_b128 v[104:107], v12 offset:2560
    ds_read_b128 v[108:111], v12 offset:2624
    v_mfma_f32_16x16x32_f16 v[112:115], v[48:51], v[64:67], v[112:115]
    v_mfma_f32_16x16x32_f16 v[116:119], v[52:55], v[64:67], v[116:119]
    v_mfma_f32_16x16x32_f16 v[120:123], v[56:59], v[64:67], v[120:123]
    v_mfma_f32_16x16x32_f16 v[124:127], v[60:63], v[64:67], v[124:127]
    v_mfma_f32_16x16x32_f16 v[128:131], v[48:51], v[72:75], v[128:131]
    v_mfma_f32_16x16x32_f16 v[132:135], v[52:55], v[72:75], v[132:135]
    v_mfma_f32_16x16x32_f16 v[136:139], v[56:59], v[72:75], v[136:139]
    v_mfma_f32_16x16x32_f16 v[140:143], v[60:63], v[72:75], v[140:143]
    v_mfma_f32_16x16x32_f16 v[120:123], v[48:51], v[68:71], v[120:123]
    v_mfma_f32_16x16x32_f16 v[124:127], v[52:55], v[68:71], v[124:127]
    v_mfma_f32_16x16x32_f16 v[136:139], v[48:51], v[76:79], v[136:139]
    v_mfma_f32_16x16x32_f16 v[140:143], v[52:55], v[76:79], v[140:143]
    s_waitcnt lgkmcnt(0)
    v_mfma_f32_16x16x32_f16 v[112:115], v[56:59], v[100:103], v[112:115]
    v_mfma_f32_16x16x32_f16 v[116:119], v[60:63], v[100:103], v[116:119]
    v_mfma_f32_16x16x32_f16 v[128:131], v[56:59], v[108:111], v[128:131]
    v_mfma_f32_16x16x32_f16 v[132:135], v[60:63], v[108:111], v[132:135]
    v_subrev_u32 v11, 128, v11
    v_subrev_u32 v12, 160, v12
    ds_read_b128 v[48:51], v11 offset:96
    ds_read_b128 v[52:55], v11 offset:64
    ds_read_b128 v[56:59], v11 offset:32
    ds_read_b128 v[60:63], v11 offset:0
    ds_read_b128 v[64:67], v12 offset:0
    ds_read_b128 v[68:71], v12 offset:64
    ds_read_b128 v[72:75], v12 offset:2560
    ds_read_b128 v[76:79], v12 offset:2624
    v_mfma_f32_16x16x32_f16 v[112:115], v[80:83], v[96:99], v[112:115]
    v_mfma_f32_16x16x32_f16 v[116:119], v[84:87], v[96:99], v[116:119]
    v_mfma_f32_16x16x32_f16 v[120:123], v[88:91], v[96:99], v[120:123]
    v_mfma_f32_16x16x32_f16 v[124:127], v[92:95], v[96:99], v[124:127]
    v_mfma_f32_16x16x32_f16 v[128:131], v[80:83], v[104:107], v[128:131]
    v_mfma_f32_16x16x32_f16 v[132:135], v[84:87], v[104:107], v[132:135]
    v_mfma_f32_16x16x32_f16 v[136:139], v[88:91], v[104:107], v[136:139]
    v_mfma_f32_16x16x32_f16 v[140:143], v[92:95], v[104:107], v[140:143]
    v_mfma_f32_16x16x32_f16 v[120:123], v[80:83], v[100:103], v[120:123]
    v_mfma_f32_16x16x32_f16 v[124:127], v[84:87], v[100:103], v[124:127]
    v_mfma_f32_16x16x32_f16 v[136:139], v[80:83], v[108:111], v[136:139]
    v_mfma_f32_16x16x32_f16 v[140:143], v[84:87], v[108:111], v[140:143]
    s_sub_u32 s54, s54, 1
    s_cmp_lg_u32 s54, 0
    s_cbranch_scc1 K2_L2
K2_L1PRE:
    s_cmp_eq_u32 s55, 0
    s_cbranch_scc1 K2_RED
K2_L1:
    s_waitcnt lgkmcnt(0)
    v_mfma_f32_16x16x32_f16 v[128:131], v[88:91], v[76:79], v[128:131]
    v_mfma_f32_16x16x32_f16 v[132:135], v[92:95], v[76:79], v[132:135]
    v_subrev_u32 v11, 128, v11
    v_subrev_u32 v12, 160, v12
    ds_read_b128 v[80:83], v11 offset:96
    ds_read_b128 v[84:87], v11 offset:64
    ds_read_b128 v[88:91], v11 offset:32
    ds_read_b128 v[92:95], v11 offset:0
    ds_read_b128 v[104:107], v12 offset:2560
    ds_read_b128 v[108:111], v12 offset:2624
    v_mfma_f32_16x16x32_f16 v[128:131], v[48:51], v[72:75], v[128:131]
    v_mfma_f32_16x16x32_f16 v[132:135], v[52:55], v[72:75], v[132:135]
    v_mfma_f32_16x16x32_f16 v[136:139], v[56:59], v[72:75], v[136:139]
    v_mfma_f32_16x16x32_f16 v[140:143], v[60:63], v[72:75], v[140:143]
    v_mfma_f32_16x16x32_f16 v[136:139], v[48:51], v[76:79], v[136:139]
    v_mfma_f32_16x16x32_f16 v[140:143], v[52:55], v[76:79], v[140:143]
    s_waitcnt lgkmcnt(0)
    v_mfma_f32_16x16x32_f16 v[128:131], v[56:59], v[108:111], v[128:131]
    v_mfma_f32_16x16x32_f16 v[132:135], v[60:63], v[108:111], v[132:135]
    v_subrev_u32 v11, 128, v11
    v_subrev_u32 v12, 160, v12
    ds_read_b128 v[48:51], v11 offset:96
    ds_read_b128 v[52:55], v11 offset:64
    ds_read_b128 v[56:59], v11 offset:32
    ds_read_b128 v[60:63], v11 offset:0
    ds_read_b128 v[72:75], v12 offset:2560
    ds_read_b128 v[76:79], v12 offset:2624
    v_mfma_f32_16x16x32_f16 v[128:131], v[80:83], v[104:107], v[128:131]
    v_mfma_f32_16x16x32_f16 v[132:135], v[84:87], v[104:107], v[132:135]
    v_mfma_f32_16x16x32_f16 v[136:139], v[88:91], v[104:107], v[136:139]
    v_mfma_f32_16x16x32_f16 v[140:143], v[92:95], v[104:107], v[140:143]
    v_mfma_f32_16x16x32_f16 v[136:139], v[80:83], v[108:111], v[136:139]
    v_mfma_f32_16x16x32_f16 v[140:143], v[84:87], v[108:111], v[140:143]
    s_sub_u32 s55, s55, 1
    s_cmp_lg_u32 s55, 0
    s_cbranch_scc1 K2_L1
K2_RED:
    s_waitcnt lgkmcnt(0)
    s_nop 11
    s_barrier
    v_mul_u32_u24 v13, 8704, v10
    v_mul_u32_u24 v14, 272, v8
    v_add_u32 v13, v13, v14
    v_lshl_add_u32 v13, v9, 4, v13
    ds_write_b128 v13, v[112:115] offset:0
    ds_write_b128 v13, v[116:119] offset:64
    ds_write_b128 v13, v[120:123] offset:128
    ds_write_b128 v13, v[124:127] offset:192
    ds_write_b128 v13, v[128:131] offset:4352
    ds_write_b128 v13, v[132:135] offset:4416
    ds_write_b128 v13, v[136:139] offset:4480
    ds_write_b128 v13, v[140:143] offset:4544
    s_waitcnt lgkmcnt(0)
    s_barrier
    v_lshrrev_b32 v13, 3, v0
    v_mul_u32_u24 v13, 272, v13
    v_lshl_add_u32 v13, v7, 5, v13
    ds_read_b128 v[48:51], v13 offset:0
    ds_read_b128 v[52:55], v13 offset:16
    ds_read_b128 v[56:59], v13 offset:8704
    ds_read_b128 v[60:63], v13 offset:8720
    ds_read_b128 v[64:67], v13 offset:17408
    ds_read_b128 v[68:71], v13 offset:17424
    ds_read_b128 v[72:75], v13 offset:26112
    ds_read_b128 v[76:79], v13 offset:26128
    v_lshlrev_b32 v149, 16, v152
    s_waitcnt lgkmcnt(0)
    v_add_f32 v48, v48, v56
    v_add_f32 v64, v64, v72
    v_add_f32 v49, v49, v57
    v_add_f32 v65, v65, v73
    v_add_f32 v50, v50, v58
    v_add_f32 v66, v66, v74
    v_add_f32 v51, v51, v59
    v_add_f32 v67, v67, v75
    v_add_f32 v52, v52, v60
    v_add_f32 v68, v68, v76
    v_add_f32 v53, v53, v61
    v_add_f32 v69, v69, v77
    v_add_f32 v54, v54, v62
    v_add_f32 v70, v70, v78
    v_add_f32 v55, v55, v63
    v_add_f32 v71, v71, v79
    v_add_f32 v48, v48, v64
    v_add_f32 v49, v49, v65
    v_add_f32 v50, v50, v66
    v_add_f32 v51, v51, v67
    v_add_f32 v52, v52, v68
    v_add_f32 v53, v53, v69
    v_add_f32 v54, v54, v70
    v_add_f32 v55, v55, v71
    v_mul_f32 v48, v48, v148
    v_mul_f32 v49, v49, v148
    v_mul_f32 v50, v50, v148
    v_mul_f32 v51, v51, v148
    v_mul_f32 v52, v52, v148
    v_mul_f32 v53, v53, v148
    v_mul_f32 v54, v54, v148
    v_mul_f32 v55, v55, v148
    v_cvt_pk_bf16_f32 v64, v48, v49
    v_cvt_pk_bf16_f32 v68, v50, v51
    v_cvt_pk_bf16_f32 v72, v52, v53
    v_cvt_pk_bf16_f32 v76, v54, v55
    v_lshlrev_b32 v48, 16, v64
    v_lshlrev_b32 v50, 16, v68
    v_lshlrev_b32 v52, 16, v72
    v_lshlrev_b32 v54, 16, v76
    v_and_b32 v49, 0xffff0000, v64
    v_and_b32 v51, 0xffff0000, v68
    v_and_b32 v53, 0xffff0000, v72
    v_and_b32 v55, 0xffff0000, v76
    v_lshlrev_b32 v65, 16, v144
    v_lshlrev_b32 v69, 16, v145
    v_lshlrev_b32 v73, 16, v146
    v_lshlrev_b32 v77, 16, v147
    v_and_b32 v66, 0xffff0000, v144
    v_and_b32 v70, 0xffff0000, v145
    v_and_b32 v74, 0xffff0000, v146
    v_and_b32 v78, 0xffff0000, v147
    v_mul_f32 v65, v65, v149
    v_mul_f32 v69, v69, v149
    v_mul_f32 v73, v73, v149
    v_mul_f32 v77, v77, v149
    v_mul_f32 v66, v66, v149
    v_mul_f32 v70, v70, v149
    v_mul_f32 v74, v74, v149
    v_mul_f32 v78, v78, v149
    v_cvt_pk_bf16_f32 v64, v65, v66
    v_cvt_pk_bf16_f32 v68, v69, v70
    v_cvt_pk_bf16_f32 v72, v73, v74
    v_cvt_pk_bf16_f32 v76, v77, v78
    v_lshlrev_b32 v65, 16, v64
    v_lshlrev_b32 v69, 16, v68
    v_lshlrev_b32 v73, 16, v72
    v_lshlrev_b32 v77, 16, v76
    v_and_b32 v66, 0xffff0000, v64
    v_and_b32 v70, 0xffff0000, v68
    v_and_b32 v74, 0xffff0000, v72
    v_and_b32 v78, 0xffff0000, v76
    v_add_f32 v48, v48, v65
    v_add_f32 v50, v50, v69
    v_add_f32 v52, v52, v73
    v_add_f32 v54, v54, v77
    v_add_f32 v49, v49, v66
    v_add_f32 v51, v51, v70
    v_add_f32 v53, v53, v74
    v_add_f32 v55, v55, v78
    v_cvt_pk_bf16_f32 v56, v48, v49
    v_cvt_pk_bf16_f32 v57, v50, v51
    v_cvt_pk_bf16_f32 v58, v52, v53
    v_cvt_pk_bf16_f32 v59, v54, v55
    buffer_store_dwordx4 v[56:59], v150, s[44:47], 0 offen
    s_endpgm
K2_LN:
    s_setprio 3
    s_sub_u32 s2, s2, 512
    s_load_dwordx2 s[4:5], s[0:1], 0
    s_load_dwordx4 s[12:15], s[0:1], 104
    s_mov_b32 s50, 0x3727c5ac
    s_mov_b32 s51, 0x3b000000
    v_and_b32 v1, 63, v0
    v_lshrrev_b32 v2, 6, v0
    s_lshl_b32 s6, s2, 14
    v_lshlrev_b32 v3, 12, v2
    v_lshl_add_u32 v3, v1, 4, v3
    v_add_u32 v3, s6, v3
    s_waitcnt lgkmcnt(0)
    s_mov_b32 s16, s4
    s_mov_b32 s17, s5
    s_mov_b32 s18, 0x200000
    s_mov_b32 s19, 0x00020000
    buffer_load_dwordx4 v[16:19], v3, s[16:19], 0 offen offset:0
    buffer_load_dwordx4 v[20:23], v3, s[16:19], 0 offen offset:1024
    buffer_load_dwordx4 v[24:27], v3, s[16:19], 0 offen offset:2048
    buffer_load_dwordx4 v[28:31], v3, s[16:19], 0 offen offset:3072
    s_mov_b32 s20, s14
    s_mov_b32 s21, s15
    s_mov_b32 s22, 0x200000
    s_mov_b32 s23, 0x00020000
    s_mov_b32 s24, s12
    s_mov_b32 s25, s13
    s_mov_b32 s26, 0x100
    s_mov_b32 s27, 0x00020000
    v_mul_u32_u24 v4, 264, v1
    v_lshl_add_u32 v4, v2, 3, v4
    v_lshrrev_b32 v5, 1, v0
    v_lshlrev_b32 v6, 5, v5
    v_lshrrev_b32 v5, 3, v5
    v_lshl_add_u32 v6, v5, 3, v6
    v_and_b32 v5, 1, v0
    v_lshl_add_u32 v6, v5, 4, v6
    v_lshlrev_b32 v7, 4, v0
    v_add_u32 v7, s6, v7
    v_add_u32 v8, 4096, v7
    v_add_u32 v9, 8192, v7
    v_add_u32 v10, 12288, v7
    s_waitcnt vmcnt(0)
    v_lshlrev_b32 v32, 16, v16
    v_and_b32 v33, 0xffff0000, v16
    v_lshlrev_b32 v34, 16, v17
    v_and_b32 v35, 0xffff0000, v17
    v_lshlrev_b32 v36, 16, v18
    v_and_b32 v37, 0xffff0000, v18
    v_lshlrev_b32 v38, 16, v19
    v_and_b32 v39, 0xffff0000, v19
    v_lshlrev_b32 v40, 16, v20
    v_and_b32 v41, 0xffff0000, v20
    v_lshlrev_b32 v42, 16, v21
    v_and_b32 v43, 0xffff0000, v21
    v_lshlrev_b32 v44, 16, v22
    v_and_b32 v45, 0xffff0000, v22
    v_lshlrev_b32 v46, 16, v23
    v_and_b32 v47, 0xffff0000, v23
    v_lshlrev_b32 v48, 16, v24
    v_and_b32 v49, 0xffff0000, v24
    v_lshlrev_b32 v50, 16, v25
    v_and_b32 v51, 0xffff0000, v25
    v_lshlrev_b32 v52, 16, v26
    v_and_b32 v53, 0xffff0000, v26
    v_lshlrev_b32 v54, 16, v27
    v_and_b32 v55, 0xffff0000, v27
    v_lshlrev_b32 v56, 16, v28
    v_and_b32 v57, 0xffff0000, v28
    v_lshlrev_b32 v58, 16, v29
    v_and_b32 v59, 0xffff0000, v29
    v_lshlrev_b32 v60, 16, v30
    v_and_b32 v61, 0xffff0000, v30
    v_lshlrev_b32 v62, 16, v31
    v_and_b32 v63, 0xffff0000, v31
    v_add_f32 v64, v32, v33
    v_add_f32 v68, v34, v35
    v_add_f32 v72, v36, v37
    v_add_f32 v76, v38, v39
    v_add_f32 v65, v40, v41
    v_add_f32 v69, v42, v43
    v_add_f32 v73, v44, v45
    v_add_f32 v77, v46, v47
    v_add_f32 v66, v48, v49
    v_add_f32 v70, v50, v51
    v_add_f32 v74, v52, v53
    v_add_f32 v78, v54, v55
    v_add_f32 v67, v56, v57
    v_add_f32 v71, v58, v59
    v_add_f32 v75, v60, v61
    v_add_f32 v79, v62, v63
    v_add_f32 v64, v64, v68
    v_add_f32 v72, v72, v76
    v_add_f32 v65, v65, v69
    v_add_f32 v73, v73, v77
    v_add_f32 v66, v66, v70
    v_add_f32 v74, v74, v78
    v_add_f32 v67, v67, v71
    v_add_f32 v75, v75, v79
    v_add_f32 v64, v64, v72
    v_add_f32 v65, v65, v73
    v_add_f32 v66, v66, v74
    v_add_f32 v67, v67, v75
    v_add_f32_dpp v64, v64, v64 row_ror:8 row_mask:0xf bank_mask:0xf
    v_add_f32_dpp v65, v65, v65 row_ror:8 row_mask:0xf bank_mask:0xf
    v_add_f32_dpp v66, v66, v66 row_ror:8 row_mask:0xf bank_mask:0xf
    v_add_f32_dpp v67, v67, v67 row_ror:8 row_mask:0xf bank_mask:0xf
    v_add_f32_dpp v64, v64, v64 row_ror:4 row_mask:0xf bank_mask:0xf
    v_add_f32_dpp v65, v65, v65 row_ror:4 row_mask:0xf bank_mask:0xf
    v_add_f32_dpp v66, v66, v66 row_ror:4 row_mask:0xf bank_mask:0xf
    v_add_f32_dpp v67, v67, v67 row_ror:4 row_mask:0xf bank_mask:0xf
    v_add_f32_dpp v64, v64, v64 row_ror:2 row_mask:0xf bank_mask:0xf
    v_add_f32_dpp v65, v65, v65 row_ror:2 row_mask:0xf bank_mask:0xf
    v_add_f32_dpp v66, v66, v66 row_ror:2 row_mask:0xf bank_mask:0xf
    v_add_f32_dpp v67, v67, v67 row_ror:2 row_mask:0xf bank_mask:0xf
    v_add_f32_dpp v64, v64, v64 row_ror:1 row_mask:0xf bank_mask:0xf
    v_add_f32_dpp v65, v65, v65 row_ror:1 row_mask:0xf bank_mask:0xf
    v_add_f32_dpp v66, v66, v66 row_ror:1 row_mask:0xf bank_mask:0xf
    v_add_f32_dpp v67, v67, v67 row_ror:1 row_mask:0xf bank_mask:0xf
    v_mov_b32 v68, v64
    v_mov_b32 v69, v65
    v_mov_b32 v70, v66
    v_mov_b32 v71, v67
    v_permlane16_swap_b32 v64, v68
    v_permlane16_swap_b32 v65, v69
    v_permlane16_swap_b32 v66, v70
    v_permlane16_swap_b32 v67, v71
    v_add_f32 v64, v64, v68
    v_add_f32 v65, v65, v69
    v_add_f32 v66, v66, v70
    v_add_f32 v67, v67, v71
    v_mov_b32 v68, v64
    v_mov_b32 v69, v65
    v_mov_b32 v70, v66
    v_mov_b32 v71, v67
    v_permlane32_swap_b32 v64, v68
    v_permlane32_swap_b32 v65, v69
    v_permlane32_swap_b32 v66, v70
    v_permlane32_swap_b32 v67, v71
    v_add_f32 v64, v64, v68
    v_add_f32 v65, v65, v69
    v_add_f32 v66, v66, v70
    v_add_f32 v67, v67, v71
    v_mul_f32 v64, s51, v64
    v_mul_f32 v65, s51, v65
    v_mul_f32 v66, s51, v66
    v_mul_f32 v67, s51, v67
    v_sub_f32 v68, v32, v64
    v_sub_f32 v76, v36, v64
    v_sub_f32 v69, v40, v65
    v_sub_f32 v77, v44, v65
    v_sub_f32 v70, v48, v66
    v_sub_f32 v78, v52, v66
    v_sub_f32 v71, v56, v67
    v_sub_f32 v79, v60, v67
    v_mul_f32 v72, v68, v68
    v_mul_f32 v80, v76, v76
    v_mul_f32 v73, v69, v69
    v_mul_f32 v81, v77, v77
    v_mul_f32 v74, v70, v70
    v_mul_f32 v82, v78, v78
    v_mul_f32 v75, v71, v71
    v_mul_f32 v83, v79, v79
    v_sub_f32 v68, v33, v64
    v_sub_f32 v76, v37, v64
    v_sub_f32 v69, v41, v65
    v_sub_f32 v77, v45, v65
    v_sub_f32 v70, v49, v66
    v_sub_f32 v78, v53, v66
    v_sub_f32 v71, v57, v67
    v_sub_f32 v79, v61, v67
    v_fmac_f32 v72, v68, v68
    v_fmac_f32 v80, v76, v76
    v_fmac_f32 v73, v69, v69
    v_fmac_f32 v81, v77, v77
    v_fmac_f32 v74, v70, v70
    v_fmac_f32 v82, v78, v78
    v_fmac_f32 v75, v71, v71
    v_fmac_f32 v83, v79, v79
    v_sub_f32 v68, v34, v64
    v_sub_f32 v76, v38, v64
    v_sub_f32 v69, v42, v65
    v_sub_f32 v77, v46, v65
    v_sub_f32 v70, v50, v66
    v_sub_f32 v78, v54, v66
    v_sub_f32 v71, v58, v67
    v_sub_f32 v79, v62, v67
    v_fmac_f32 v72, v68, v68
    v_fmac_f32 v80, v76, v76
    v_fmac_f32 v73, v69, v69
    v_fmac_f32 v81, v77, v77
    v_fmac_f32 v74, v70, v70
    v_fmac_f32 v82, v78, v78
    v_fmac_f32 v75, v71, v71
    v_fmac_f32 v83, v79, v79
    v_sub_f32 v68, v35, v64
    v_sub_f32 v76, v39, v64
    v_sub_f32 v69, v43, v65
    v_sub_f32 v77, v47, v65
    v_sub_f32 v70, v51, v66
    v_sub_f32 v78, v55, v66
    v_sub_f32 v71, v59, v67
    v_sub_f32 v79, v63, v67
    v_fmac_f32 v72, v68, v68
    v_fmac_f32 v80, v76, v76
    v_fmac_f32 v73, v69, v69
    v_fmac_f32 v81, v77, v77
    v_fmac_f32 v74, v70, v70
    v_fmac_f32 v82, v78, v78
    v_fmac_f32 v75, v71, v71
    v_fmac_f32 v83, v79, v79
    v_add_f32 v72, v72, v80
    v_add_f32 v73, v73, v81
    v_add_f32 v74, v74, v82
    v_add_f32 v75, v75, v83
    v_add_f32_dpp v72, v72, v72 row_ror:8 row_mask:0xf bank_mask:0xf
    v_add_f32_dpp v73, v73, v73 row_ror:8 row_mask:0xf bank_mask:0xf
    v_add_f32_dpp v74, v74, v74 row_ror:8 row_mask:0xf bank_mask:0xf
    v_add_f32_dpp v75, v75, v75 row_ror:8 row_mask:0xf bank_mask:0xf
    v_add_f32_dpp v72, v72, v72 row_ror:4 row_mask:0xf bank_mask:0xf
    v_add_f32_dpp v73, v73, v73 row_ror:4 row_mask:0xf bank_mask:0xf
    v_add_f32_dpp v74, v74, v74 row_ror:4 row_mask:0xf bank_mask:0xf
    v_add_f32_dpp v75, v75, v75 row_ror:4 row_mask:0xf bank_mask:0xf
    v_add_f32_dpp v72, v72, v72 row_ror:2 row_mask:0xf bank_mask:0xf
    v_add_f32_dpp v73, v73, v73 row_ror:2 row_mask:0xf bank_mask:0xf
    v_add_f32_dpp v74, v74, v74 row_ror:2 row_mask:0xf bank_mask:0xf
    v_add_f32_dpp v75, v75, v75 row_ror:2 row_mask:0xf bank_mask:0xf
    v_add_f32_dpp v72, v72, v72 row_ror:1 row_mask:0xf bank_mask:0xf
    v_add_f32_dpp v73, v73, v73 row_ror:1 row_mask:0xf bank_mask:0xf
    v_add_f32_dpp v74, v74, v74 row_ror:1 row_mask:0xf bank_mask:0xf
    v_add_f32_dpp v75, v75, v75 row_ror:1 row_mask:0xf bank_mask:0xf
    v_mov_b32 v68, v72
    v_mov_b32 v69, v73
    v_mov_b32 v70, v74
    v_mov_b32 v71, v75
    v_permlane16_swap_b32 v72, v68
    v_permlane16_swap_b32 v73, v69
    v_permlane16_swap_b32 v74, v70
    v_permlane16_swap_b32 v75, v71
    v_add_f32 v72, v72, v68
    v_add_f32 v73, v73, v69
    v_add_f32 v74, v74, v70
    v_add_f32 v75, v75, v71
    v_mov_b32 v68, v72
    v_mov_b32 v69, v73
    v_mov_b32 v70, v74
    v_mov_b32 v71, v75
    v_permlane32_swap_b32 v72, v68
    v_permlane32_swap_b32 v73, v69
    v_permlane32_swap_b32 v74, v70
    v_permlane32_swap_b32 v75, v71
    v_add_f32 v72, v72, v68
    v_add_f32 v73, v73, v69
    v_add_f32 v74, v74, v70
    v_add_f32 v75, v75, v71
    v_mul_f32 v72, s51, v72
    v_mul_f32 v73, s51, v73
    v_mul_f32 v74, s51, v74
    v_mul_f32 v75, s51, v75
    v_cvt_pk_bf16_f32 v68, v64, v72
    v_cvt_pk_bf16_f32 v69, v65, v73
    v_cvt_pk_bf16_f32 v70, v66, v74
    v_cvt_pk_bf16_f32 v71, v67, v75
    v_lshlrev_b32 v64, 16, v68
    v_lshlrev_b32 v65, 16, v69
    v_lshlrev_b32 v66, 16, v70
    v_lshlrev_b32 v67, 16, v71
    v_and_b32 v72, 0xffff0000, v68
    v_and_b32 v73, 0xffff0000, v69
    v_and_b32 v74, 0xffff0000, v70
    v_and_b32 v75, 0xffff0000, v71
    v_add_f32 v72, s50, v72
    v_add_f32 v73, s50, v73
    v_add_f32 v74, s50, v74
    v_add_f32 v75, s50, v75
    v_cvt_pk_bf16_f32 v68, v72, v73
    v_cvt_pk_bf16_f32 v70, v74, v75
    v_lshlrev_b32 v72, 16, v68
    v_lshlrev_b32 v74, 16, v70
    v_and_b32 v73, 0xffff0000, v68
    v_and_b32 v75, 0xffff0000, v70
    v_sqrt_f32 v80, v72
    v_sqrt_f32 v81, v73
    v_sqrt_f32 v82, v74
    v_sqrt_f32 v83, v75
    v_rcp_f32 v76, v80
    v_rcp_f32 v77, v81
    v_rcp_f32 v78, v82
    v_rcp_f32 v79, v83
    v_fma_f32 v68, -v80, v80, v72
    v_fma_f32 v69, -v81, v81, v73
    v_fma_f32 v70, -v82, v82, v74
    v_fma_f32 v71, -v83, v83, v75
    v_mul_f32 v76, 0.5, v76
    v_mul_f32 v77, 0.5, v77
    v_mul_f32 v78, 0.5, v78
    v_mul_f32 v79, 0.5, v79
    v_fma_f32 v80, v68, v76, v80
    v_fma_f32 v81, v69, v77, v81
    v_fma_f32 v82, v70, v78, v82
    v_fma_f32 v83, v71, v79, v83
    v_cvt_pk_bf16_f32 v68, v80, v81
    v_cvt_pk_bf16_f32 v70, v82, v83
    v_lshlrev_b32 v80, 16, v68
    v_lshlrev_b32 v82, 16, v70
    v_and_b32 v81, 0xffff0000, v68
    v_and_b32 v83, 0xffff0000, v70
    v_rcp_f32 v76, v80
    v_rcp_f32 v77, v81
    v_rcp_f32 v78, v82
    v_rcp_f32 v79, v83
    v_fma_f32 v68, -v80, v76, 1.0
    v_fma_f32 v69, -v81, v77, 1.0
    v_fma_f32 v70, -v82, v78, 1.0
    v_fma_f32 v71, -v83, v79, 1.0
    v_fma_f32 v76, v68, v76, v76
    v_fma_f32 v77, v69, v77, v77
    v_fma_f32 v78, v70, v78, v78
    v_fma_f32 v79, v71, v79, v79
    v_sub_f32 v32, v32, v64
    v_sub_f32 v36, v36, v64
    v_sub_f32 v40, v40, v65
    v_sub_f32 v44, v44, v65
    v_sub_f32 v48, v48, v66
    v_sub_f32 v52, v52, v66
    v_sub_f32 v56, v56, v67
    v_sub_f32 v60, v60, v67
    v_sub_f32 v33, v33, v64
    v_sub_f32 v37, v37, v64
    v_sub_f32 v41, v41, v65
    v_sub_f32 v45, v45, v65
    v_sub_f32 v49, v49, v66
    v_sub_f32 v53, v53, v66
    v_sub_f32 v57, v57, v67
    v_sub_f32 v61, v61, v67
    v_cvt_pk_bf16_f32 v84, v32, v33
    v_cvt_pk_bf16_f32 v86, v36, v37
    v_cvt_pk_bf16_f32 v88, v40, v41
    v_cvt_pk_bf16_f32 v90, v44, v45
    v_cvt_pk_bf16_f32 v92, v48, v49
    v_cvt_pk_bf16_f32 v94, v52, v53
    v_cvt_pk_bf16_f32 v96, v56, v57
    v_cvt_pk_bf16_f32 v98, v60, v61
    v_lshlrev_b32 v32, 16, v84
    v_lshlrev_b32 v36, 16, v86
    v_lshlrev_b32 v40, 16, v88
    v_lshlrev_b32 v44, 16, v90
    v_lshlrev_b32 v48, 16, v92
    v_lshlrev_b32 v52, 16, v94
    v_lshlrev_b32 v56, 16, v96
    v_lshlrev_b32 v60, 16, v98
    v_and_b32 v33, 0xffff0000, v84
    v_and_b32 v37, 0xffff0000, v86
    v_and_b32 v41, 0xffff0000, v88
    v_and_b32 v45, 0xffff0000, v90
    v_and_b32 v49, 0xffff0000, v92
    v_and_b32 v53, 0xffff0000, v94
    v_and_b32 v57, 0xffff0000, v96
    v_and_b32 v61, 0xffff0000, v98
    v_mul_f32 v84, v32, v76
    v_mul_f32 v86, v36, v76
    v_mul_f32 v88, v40, v77
    v_mul_f32 v90, v44, v77
    v_mul_f32 v92, v48, v78
    v_mul_f32 v94, v52, v78
    v_mul_f32 v96, v56, v79
    v_mul_f32 v98, v60, v79
    v_mul_f32 v85, v33, v76
    v_mul_f32 v87, v37, v76
    v_mul_f32 v89, v41, v77
    v_mul_f32 v91, v45, v77
    v_mul_f32 v93, v49, v78
    v_mul_f32 v95, v53, v78
    v_mul_f32 v97, v57, v79
    v_mul_f32 v99, v61, v79
    v_fma_f32 v32, -v84, v80, v32
    v_fma_f32 v36, -v86, v80, v36
    v_fma_f32 v40, -v88, v81, v40
    v_fma_f32 v44, -v90, v81, v44
    v_fma_f32 v48, -v92, v82, v48
    v_fma_f32 v52, -v94, v82, v52
    v_fma_f32 v56, -v96, v83, v56
    v_fma_f32 v60, -v98, v83, v60
    v_fma_f32 v33, -v85, v80, v33
    v_fma_f32 v37, -v87, v80, v37
    v_fma_f32 v41, -v89, v81, v41
    v_fma_f32 v45, -v91, v81, v45
    v_fma_f32 v49, -v93, v82, v49
    v_fma_f32 v53, -v95, v82, v53
    v_fma_f32 v57, -v97, v83, v57
    v_fma_f32 v61, -v99, v83, v61
    v_fma_f32 v32, v32, v76, v84
    v_fma_f32 v36, v36, v76, v86
    v_fma_f32 v40, v40, v77, v88
    v_fma_f32 v44, v44, v77, v90
    v_fma_f32 v48, v48, v78, v92
    v_fma_f32 v52, v52, v78, v94
    v_fma_f32 v56, v56, v79, v96
    v_fma_f32 v60, v60, v79, v98
    v_fma_f32 v33, v33, v76, v85
    v_fma_f32 v37, v37, v76, v87
    v_fma_f32 v41, v41, v77, v89
    v_fma_f32 v45, v45, v77, v91
    v_fma_f32 v49, v49, v78, v93
    v_fma_f32 v53, v53, v78, v95
    v_fma_f32 v57, v57, v79, v97
    v_fma_f32 v61, v61, v79, v99
    v_cvt_pk_bf16_f32 v84, v32, v33
    v_cvt_pk_bf16_f32 v86, v36, v37
    v_cvt_pk_bf16_f32 v88, v40, v41
    v_cvt_pk_bf16_f32 v90, v44, v45
    v_cvt_pk_bf16_f32 v92, v48, v49
    v_cvt_pk_bf16_f32 v94, v52, v53
    v_cvt_pk_bf16_f32 v96, v56, v57
    v_cvt_pk_bf16_f32 v98, v60, v61
    v_lshlrev_b32 v32, 16, v84
    v_lshlrev_b32 v36, 16, v86
    v_lshlrev_b32 v40, 16, v88
    v_lshlrev_b32 v44, 16, v90
    v_lshlrev_b32 v48, 16, v92
    v_lshlrev_b32 v52, 16, v94
    v_lshlrev_b32 v56, 16, v96
    v_lshlrev_b32 v60, 16, v98
    v_and_b32 v33, 0xffff0000, v84
    v_and_b32 v37, 0xffff0000, v86
    v_and_b32 v41, 0xffff0000, v88
    v_and_b32 v45, 0xffff0000, v90
    v_and_b32 v49, 0xffff0000, v92
    v_and_b32 v53, 0xffff0000, v94
    v_and_b32 v57, 0xffff0000, v96
    v_and_b32 v61, 0xffff0000, v98
    v_sub_f32 v34, v34, v64
    v_sub_f32 v38, v38, v64
    v_sub_f32 v42, v42, v65
    v_sub_f32 v46, v46, v65
    v_sub_f32 v50, v50, v66
    v_sub_f32 v54, v54, v66
    v_sub_f32 v58, v58, v67
    v_sub_f32 v62, v62, v67
    v_sub_f32 v35, v35, v64
    v_sub_f32 v39, v39, v64
    v_sub_f32 v43, v43, v65
    v_sub_f32 v47, v47, v65
    v_sub_f32 v51, v51, v66
    v_sub_f32 v55, v55, v66
    v_sub_f32 v59, v59, v67
    v_sub_f32 v63, v63, v67
    v_cvt_pk_bf16_f32 v84, v34, v35
    v_cvt_pk_bf16_f32 v86, v38, v39
    v_cvt_pk_bf16_f32 v88, v42, v43
    v_cvt_pk_bf16_f32 v90, v46, v47
    v_cvt_pk_bf16_f32 v92, v50, v51
    v_cvt_pk_bf16_f32 v94, v54, v55
    v_cvt_pk_bf16_f32 v96, v58, v59
    v_cvt_pk_bf16_f32 v98, v62, v63
    v_lshlrev_b32 v34, 16, v84
    v_lshlrev_b32 v38, 16, v86
    v_lshlrev_b32 v42, 16, v88
    v_lshlrev_b32 v46, 16, v90
    v_lshlrev_b32 v50, 16, v92
    v_lshlrev_b32 v54, 16, v94
    v_lshlrev_b32 v58, 16, v96
    v_lshlrev_b32 v62, 16, v98
    v_and_b32 v35, 0xffff0000, v84
    v_and_b32 v39, 0xffff0000, v86
    v_and_b32 v43, 0xffff0000, v88
    v_and_b32 v47, 0xffff0000, v90
    v_and_b32 v51, 0xffff0000, v92
    v_and_b32 v55, 0xffff0000, v94
    v_and_b32 v59, 0xffff0000, v96
    v_and_b32 v63, 0xffff0000, v98
    v_mul_f32 v84, v34, v76
    v_mul_f32 v86, v38, v76
    v_mul_f32 v88, v42, v77
    v_mul_f32 v90, v46, v77
    v_mul_f32 v92, v50, v78
    v_mul_f32 v94, v54, v78
    v_mul_f32 v96, v58, v79
    v_mul_f32 v98, v62, v79
    v_mul_f32 v85, v35, v76
    v_mul_f32 v87, v39, v76
    v_mul_f32 v89, v43, v77
    v_mul_f32 v91, v47, v77
    v_mul_f32 v93, v51, v78
    v_mul_f32 v95, v55, v78
    v_mul_f32 v97, v59, v79
    v_mul_f32 v99, v63, v79
    v_fma_f32 v34, -v84, v80, v34
    v_fma_f32 v38, -v86, v80, v38
    v_fma_f32 v42, -v88, v81, v42
    v_fma_f32 v46, -v90, v81, v46
    v_fma_f32 v50, -v92, v82, v50
    v_fma_f32 v54, -v94, v82, v54
    v_fma_f32 v58, -v96, v83, v58
    v_fma_f32 v62, -v98, v83, v62
    v_fma_f32 v35, -v85, v80, v35
    v_fma_f32 v39, -v87, v80, v39
    v_fma_f32 v43, -v89, v81, v43
    v_fma_f32 v47, -v91, v81, v47
    v_fma_f32 v51, -v93, v82, v51
    v_fma_f32 v55, -v95, v82, v55
    v_fma_f32 v59, -v97, v83, v59
    v_fma_f32 v63, -v99, v83, v63
    v_fma_f32 v34, v34, v76, v84
    v_fma_f32 v38, v38, v76, v86
    v_fma_f32 v42, v42, v77, v88
    v_fma_f32 v46, v46, v77, v90
    v_fma_f32 v50, v50, v78, v92
    v_fma_f32 v54, v54, v78, v94
    v_fma_f32 v58, v58, v79, v96
    v_fma_f32 v62, v62, v79, v98
    v_fma_f32 v35, v35, v76, v85
    v_fma_f32 v39, v39, v76, v87
    v_fma_f32 v43, v43, v77, v89
    v_fma_f32 v47, v47, v77, v91
    v_fma_f32 v51, v51, v78, v93
    v_fma_f32 v55, v55, v78, v95
    v_fma_f32 v59, v59, v79, v97
    v_fma_f32 v63, v63, v79, v99
    v_cvt_pk_bf16_f32 v84, v34, v35
    v_cvt_pk_bf16_f32 v86, v38, v39
    v_cvt_pk_bf16_f32 v88, v42, v43
    v_cvt_pk_bf16_f32 v90, v46, v47
    v_cvt_pk_bf16_f32 v92, v50, v51
    v_cvt_pk_bf16_f32 v94, v54, v55
    v_cvt_pk_bf16_f32 v96, v58, v59
    v_cvt_pk_bf16_f32 v98, v62, v63
    v_lshlrev_b32 v34, 16, v84
    v_lshlrev_b32 v38, 16, v86
    v_lshlrev_b32 v42, 16, v88
    v_lshlrev_b32 v46, 16, v90
    v_lshlrev_b32 v50, 16, v92
    v_lshlrev_b32 v54, 16, v94
    v_lshlrev_b32 v58, 16, v96
    v_lshlrev_b32 v62, 16, v98
    v_and_b32 v35, 0xffff0000, v84
    v_and_b32 v39, 0xffff0000, v86
    v_and_b32 v43, 0xffff0000, v88
    v_and_b32 v47, 0xffff0000, v90
    v_and_b32 v51, 0xffff0000, v92
    v_and_b32 v55, 0xffff0000, v94
    v_and_b32 v59, 0xffff0000, v96
    v_and_b32 v63, 0xffff0000, v98
    v_cvt_pk_bf16_f32 v16, v32, v40
    v_cvt_pk_bf16_f32 v17, v48, v56
    v_cvt_pk_bf16_f32 v18, v33, v41
    v_cvt_pk_bf16_f32 v19, v49, v57
    v_cvt_pk_bf16_f32 v20, v34, v42
    v_cvt_pk_bf16_f32 v21, v50, v58
    v_cvt_pk_bf16_f32 v22, v35, v43
    v_cvt_pk_bf16_f32 v23, v51, v59
    v_cvt_pk_bf16_f32 v24, v36, v44
    v_cvt_pk_bf16_f32 v25, v52, v60
    v_cvt_pk_bf16_f32 v26, v37, v45
    v_cvt_pk_bf16_f32 v27, v53, v61
    v_cvt_pk_bf16_f32 v28, v38, v46
    v_cvt_pk_bf16_f32 v29, v54, v62
    v_cvt_pk_bf16_f32 v30, v39, v47
    v_cvt_pk_bf16_f32 v31, v55, v63
    ds_write_b64 v4, v[16:17] offset:0
    ds_write_b64 v4, v[18:19] offset:32
    ds_write_b64 v4, v[20:21] offset:64
    ds_write_b64 v4, v[22:23] offset:96
    ds_write_b64 v4, v[24:25] offset:128
    ds_write_b64 v4, v[26:27] offset:160
    ds_write_b64 v4, v[28:29] offset:192
    ds_write_b64 v4, v[30:31] offset:224
    s_waitcnt lgkmcnt(0)
    s_barrier
    ds_read_b64 v[16:17], v6 offset:0
    ds_read_b64 v[18:19], v6 offset:8
    ds_read_b64 v[20:21], v6 offset:4224
    ds_read_b64 v[22:23], v6 offset:4232
    ds_read_b64 v[24:25], v6 offset:8448
    ds_read_b64 v[26:27], v6 offset:8456
    ds_read_b64 v[28:29], v6 offset:12672
    ds_read_b64 v[30:31], v6 offset:12680
    s_waitcnt lgkmcnt(0)
    buffer_store_dwordx4 v[16:19], v7, s[20:23], 0 offen sc1
    buffer_store_dwordx4 v[20:23], v8, s[20:23], 0 offen sc1
    buffer_store_dwordx4 v[24:27], v9, s[20:23], 0 offen sc1
    buffer_store_dwordx4 v[28:31], v10, s[20:23], 0 offen sc1
    s_waitcnt vmcnt(0)
    s_barrier
    v_mov_b32 v11, 0
    v_mov_b32 v12, 1
    v_cmp_eq_u32 vcc, 0, v0
    s_nop 0
    s_and_saveexec_b64 s[30:31], vcc
    buffer_atomic_add v12, v11, s[24:27], 0 offen sc1
    s_mov_b64 exec, s[30:31]
    s_endpgm
K2_TR:
    s_load_dwordx2 s[4:5], s[0:1], 64
    s_load_dwordx2 s[6:7], s[0:1], 80
    s_load_dwordx2 s[14:15], s[0:1], 112
    s_sub_u32 s3, s2, 640
    s_waitcnt lgkmcnt(0)
    s_cmp_ge_u32 s3, 176
    s_cbranch_scc1 K2_TR2
    s_mov_b32 s16, s4
    s_mov_b32 s17, s5
    s_mov_b32 s18, 0x158000
    s_mov_b32 s19, 0x00020000
    s_add_u32 s20, s14, 0xb00000
    s_addc_u32 s21, s15, 0
    s_mov_b32 s22, 0x158000
    s_mov_b32 s23, 0x00020000
    s_and_b32 s40, s3, 7
    s_lshr_b32 s41, s3, 3
    s_mov_b32 s42, 2752
    s_mov_b32 s43, 1024
    s_branch K2_TRC
K2_TR2:
    s_mov_b32 s16, s6
    s_mov_b32 s17, s7
    s_mov_b32 s18, 0x158000
    s_mov_b32 s19, 0x00020000
    s_add_u32 s20, s14, 0xd00000
    s_addc_u32 s21, s15, 0
    s_mov_b32 s22, 0x160000
    s_mov_b32 s23, 0x00020000
    s_sub_u32 s3, s3, 176
    s_and_b32 s41, s3, 7
    s_lshr_b32 s40, s3, 3
    s_mov_b32 s42, 1024
    s_mov_b32 s43, 2816
K2_TRC:
    v_lshrrev_b32 v1, 3, v0
    v_and_b32 v2, 7, v0
    s_lshl_b32 s44, s40, 6
    v_add_u32 v3, s44, v1
    v_mul_lo_u32 v3, v3, s42
    s_lshl_b32 s45, s41, 7
    v_lshl_add_u32 v3, v2, 4, v3
    v_add_u32 v3, s45, v3
    s_lshl_b32 s46, s42, 5
    v_add_u32 v4, s46, v3
    buffer_load_dwordx4 v[8:11], v3, s[16:19], 0 offen
    buffer_load_dwordx4 v[12:15], v4, s[16:19], 0 offen
    v_mul_u32_u24 v5, 144, v1
    v_lshl_add_u32 v5, v2, 4, v5
    v_lshrrev_b32 v6, 2, v0
    v_and_b32 v7, 3, v0
    v_mul_u32_u24 v16, 2304, v7
    v_lshl_add_u32 v16, v6, 1, v16
    s_lshl_b32 s45, s41, 6
    v_add_u32 v17, s45, v6
    v_mul_lo_u32 v17, v17, s43
    s_lshl_b32 s44, s40, 7
    v_lshl_add_u32 v17, v7, 5, v17
    v_add_u32 v17, s44, v17
    s_waitcnt vmcnt(0)
    ds_write_b128 v5, v[8:11]
    ds_write_b128 v5, v[12:15] offset:4608
    s_waitcnt lgkmcnt(0)
    s_barrier
    ds_read_u16 v32, v16 offset:0
    ds_read_u16 v33, v16 offset:144
    ds_read_u16 v34, v16 offset:288
    ds_read_u16 v35, v16 offset:432
    ds_read_u16 v36, v16 offset:576
    ds_read_u16 v37, v16 offset:720
    ds_read_u16 v38, v16 offset:864
    ds_read_u16 v39, v16 offset:1008
    ds_read_u16 v40, v16 offset:1152
    ds_read_u16 v41, v16 offset:1296
    ds_read_u16 v42, v16 offset:1440
    ds_read_u16 v43, v16 offset:1584
    ds_read_u16 v44, v16 offset:1728
    ds_read_u16 v45, v16 offset:1872
    ds_read_u16 v46, v16 offset:2016
    ds_read_u16 v47, v16 offset:2160
    s_waitcnt lgkmcnt(0)
    v_lshl_or_b32 v20, v33, 16, v32
    v_lshl_or_b32 v21, v35, 16, v34
    v_lshl_or_b32 v22, v37, 16, v36
    v_lshl_or_b32 v23, v39, 16, v38
    v_lshl_or_b32 v24, v41, 16, v40
    v_lshl_or_b32 v25, v43, 16, v42
    v_lshl_or_b32 v26, v45, 16, v44
    v_lshl_or_b32 v27, v47, 16, v46
    buffer_store_dwordx4 v[20:23], v17, s[20:23], 0 offen
    buffer_store_dwordx4 v[24:27], v17, s[20:23], 0 offen offset:16
K2_END:
    s_endpgm
.globl k3_kernel
.p2align 8
.type k3_kernel,@function
k3_kernel:
    s_cmp_ge_u32 s2, 128
    s_cbranch_scc1 K3_END
    s_load_dwordx2 s[4:5], s[0:1], 0
    s_load_dwordx2 s[14:15], s[0:1], 112
    s_mov_b32 s50, 0x3727c5ac
    s_mov_b32 s51, 0x3b000000
    v_and_b32 v1, 63, v0
    v_lshrrev_b32 v2, 6, v0
    s_lshl_b32 s6, s2, 14
    v_lshlrev_b32 v3, 11, v2
    v_lshl_add_u32 v3, v1, 4, v3
    v_add_u32 v3, s6, v3
    v_lshlrev_b32 v7, 4, v0
    v_add_u32 v7, s6, v7
    v_add_u32 v8, 8192, v7
    s_waitcnt lgkmcnt(0)
    s_add_u32 s20, s14, 0x500000
    s_addc_u32 s21, s15, 0
    s_mov_b32 s22, 0x200000
    s_mov_b32 s23, 0x00020000
    buffer_load_dwordx4 v[72:75], v7, s[20:23], 0 offen
    buffer_load_dwordx4 v[76:79], v8, s[20:23], 0 offen
    s_mov_b32 s16, s4
    s_mov_b32 s17, s5
    s_mov_b32 s18, 0x200000
    s_mov_b32 s19, 0x00020000
    buffer_load_dwordx4 v[16:19], v3, s[16:19], 0 offen offset:0
    buffer_load_dwordx4 v[20:23], v3, s[16:19], 0 offen offset:1024
    s_add_u32 s24, s14, 0x700000
    s_addc_u32 s25, s15, 0
    s_mov_b32 s26, 0x200000
    s_mov_b32 s27, 0x00020000
    s_add_u32 s28, s14, 0x900000
    s_addc_u32 s29, s15, 0
    s_mov_b32 s30, 0x200000
    s_mov_b32 s31, 0x00020000
    v_lshrrev_b32 v5, 1, v0
    v_lshlrev_b32 v6, 5, v5
    v_lshrrev_b32 v5, 3, v5
    v_lshl_add_u32 v6, v5, 3, v6
    v_and_b32 v5, 1, v0
    v_lshl_add_u32 v6, v5, 4, v6
    v_mul_u32_u24 v4, 264, v1
    v_lshl_add_u32 v4, v2, 2, v4
    s_waitcnt vmcnt(2)
    ds_write_b64 v6, v[72:73] offset:0
    ds_write_b64 v6, v[74:75] offset:8
    ds_write_b64 v6, v[76:77] offset:8448
    ds_write_b64 v6, v[78:79] offset:8456
    s_waitcnt lgkmcnt(0)
    s_barrier
    ds_read_b32 v72, v4 offset:0
    ds_read_b32 v73, v4 offset:32
    ds_read_b32 v74, v4 offset:64
    ds_read_b32 v75, v4 offset:96
    ds_read_b32 v76, v4 offset:128
    ds_read_b32 v77, v4 offset:160
    ds_read_b32 v78, v4 offset:192
    ds_read_b32 v79, v4 offset:224
    s_waitcnt vmcnt(0) lgkmcnt(0)
    v_lshlrev_b32 v32, 16, v16
    v_and_b32 v33, 0xffff0000, v16
    v_lshlrev_b32 v34, 16, v17
    v_and_b32 v35, 0xffff0000, v17
    v_lshlrev_b32 v36, 16, v18
    v_and_b32 v37, 0xffff0000, v18
    v_lshlrev_b32 v38, 16, v19
    v_and_b32 v39, 0xffff0000, v19
    v_lshlrev_b32 v40, 16, v20
    v_and_b32 v41, 0xffff0000, v20
    v_lshlrev_b32 v42, 16, v21
    v_and_b32 v43, 0xffff0000, v21
    v_lshlrev_b32 v44, 16, v22
    v_and_b32 v45, 0xffff0000, v22
    v_lshlrev_b32 v46, 16, v23
    v_and_b32 v47, 0xffff0000, v23
    v_lshlrev_b32 v48, 16, v72
    v_and_b32 v56, 0xffff0000, v72
    v_lshlrev_b32 v49, 16, v73
    v_and_b32 v57, 0xffff0000, v73
    v_lshlrev_b32 v50, 16, v74
    v_and_b32 v58, 0xffff0000, v74
    v_lshlrev_b32 v51, 16, v75
    v_and_b32 v59, 0xffff0000, v75
    v_lshlrev_b32 v52, 16, v76
    v_and_b32 v60, 0xffff0000, v76
    v_lshlrev_b32 v53, 16, v77
    v_and_b32 v61, 0xffff0000, v77
    v_lshlrev_b32 v54, 16, v78
    v_and_b32 v62, 0xffff0000, v78
    v_lshlrev_b32 v55, 16, v79
    v_and_b32 v63, 0xffff0000, v79
    v_add_f32 v32, v32, v48
    v_add_f32 v40, v40, v56
    v_add_f32 v33, v33, v49
    v_add_f32 v41, v41, v57
    v_add_f32 v34, v34, v50
    v_add_f32 v42, v42, v58
    v_add_f32 v35, v35, v51
    v_add_f32 v43, v43, v59
    v_add_f32 v36, v36, v52
    v_add_f32 v44, v44, v60
    v_add_f32 v37, v37, v53
    v_add_f32 v45, v45, v61
    v_add_f32 v38, v38, v54
    v_add_f32 v46, v46, v62
    v_add_f32 v39, v39, v55
    v_add_f32 v47, v47, v63
    v_cvt_pk_bf16_f32 v16, v32, v33
    v_cvt_pk_bf16_f32 v17, v34, v35
    v_cvt_pk_bf16_f32 v18, v36, v37
    v_cvt_pk_bf16_f32 v19, v38, v39
    v_cvt_pk_bf16_f32 v20, v40, v41
    v_cvt_pk_bf16_f32 v21, v42, v43
    v_cvt_pk_bf16_f32 v22, v44, v45
    v_cvt_pk_bf16_f32 v23, v46, v47
    v_lshlrev_b32 v32, 16, v16
    v_and_b32 v33, 0xffff0000, v16
    v_lshlrev_b32 v34, 16, v17
    v_and_b32 v35, 0xffff0000, v17
    v_lshlrev_b32 v36, 16, v18
    v_and_b32 v37, 0xffff0000, v18
    v_lshlrev_b32 v38, 16, v19
    v_and_b32 v39, 0xffff0000, v19
    v_lshlrev_b32 v40, 16, v20
    v_and_b32 v41, 0xffff0000, v20
    v_lshlrev_b32 v42, 16, v21
    v_and_b32 v43, 0xffff0000, v21
    v_lshlrev_b32 v44, 16, v22
    v_and_b32 v45, 0xffff0000, v22
    v_lshlrev_b32 v46, 16, v23
    v_and_b32 v47, 0xffff0000, v23
    buffer_store_dwordx4 v[16:19], v3, s[24:27], 0 offen offset:0
    buffer_store_dwordx4 v[20:23], v3, s[24:27], 0 offen offset:1024
    v_add_f32 v48, v32, v33
    v_add_f32 v50, v34, v35
    v_add_f32 v52, v36, v37
    v_add_f32 v54, v38, v39
    v_add_f32 v49, v40, v41
    v_add_f32 v51, v42, v43
    v_add_f32 v53, v44, v45
    v_add_f32 v55, v46, v47
    v_add_f32 v48, v48, v50
    v_add_f32 v52, v52, v54
    v_add_f32 v49, v49, v51
    v_add_f32 v53, v53, v55
    v_add_f32 v48, v48, v52
    v_add_f32 v49, v49, v53
    s_nop 0
    v_add_f32_dpp v48, v48, v48 row_ror:8 row_mask:0xf bank_mask:0xf
    v_add_f32_dpp v49, v49, v49 row_ror:8 row_mask:0xf bank_mask:0xf
    s_nop 0
    v_add_f32_dpp v48, v48, v48 row_ror:4 row_mask:0xf bank_mask:0xf
    v_add_f32_dpp v49, v49, v49 row_ror:4 row_mask:0xf bank_mask:0xf
    s_nop 0
    v_add_f32_dpp v48, v48, v48 row_ror:2 row_mask:0xf bank_mask:0xf
    v_add_f32_dpp v49, v49, v49 row_ror:2 row_mask:0xf bank_mask:0xf
    s_nop 0
    v_add_f32_dpp v48, v48, v48 row_ror:1 row_mask:0xf bank_mask:0xf
    v_add_f32_dpp v49, v49, v49 row_ror:1 row_mask:0xf bank_mask:0xf
    v_mov_b32 v50, v48
    v_mov_b32 v51, v49
    s_nop 0
    v_permlane16_swap_b32 v48, v50
    v_permlane16_swap_b32 v49, v51
    v_add_f32 v48, v48, v50
    v_add_f32 v49, v49, v51
    v_mov_b32 v50, v48
    v_mov_b32 v51, v49
    s_nop 0
    v_permlane32_swap_b32 v48, v50
    v_permlane32_swap_b32 v49, v51
    v_add_f32 v48, v48, v50
    v_add_f32 v49, v49, v51
    v_mul_f32 v48, s51, v48
    v_mul_f32 v49, s51, v49
    v_sub_f32 v50, v32, v48
    v_sub_f32 v54, v36, v48
    v_sub_f32 v51, v40, v49
    v_sub_f32 v55, v44, v49
    v_mul_f32 v52, v50, v50
    v_mul_f32 v56, v54, v54
    v_mul_f32 v53, v51, v51
    v_mul_f32 v57, v55, v55
    v_sub_f32 v50, v33, v48
    v_sub_f32 v54, v37, v48
    v_sub_f32 v51, v41, v49
    v_sub_f32 v55, v45, v49
    v_fmac_f32 v52, v50, v50
    v_fmac_f32 v56, v54, v54
    v_fmac_f32 v53, v51, v51
    v_fmac_f32 v57, v55, v55
    v_sub_f32 v50, v34, v48
    v_sub_f32 v54, v38, v48
    v_sub_f32 v51, v42, v49
    v_sub_f32 v55, v46, v49
    v_fmac_f32 v52, v50, v50
    v_fmac_f32 v56, v54, v54
    v_fmac_f32 v53, v51, v51
    v_fmac_f32 v57, v55, v55
    v_sub_f32 v50, v35, v48
    v_sub_f32 v54, v39, v48
    v_sub_f32 v51, v43, v49
    v_sub_f32 v55, v47, v49
    v_fmac_f32 v52, v50, v50
    v_fmac_f32 v56, v54, v54
    v_fmac_f32 v53, v51, v51
    v_fmac_f32 v57, v55, v55
    v_add_f32 v52, v52, v56
    v_add_f32 v53, v53, v57
    s_nop 0
    v_add_f32_dpp v52, v52, v52 row_ror:8 row_mask:0xf bank_mask:0xf
    v_add_f32_dpp v53, v53, v53 row_ror:8 row_mask:0xf bank_mask:0xf
    s_nop 0
    v_add_f32_dpp v52, v52, v52 row_ror:4 row_mask:0xf bank_mask:0xf
    v_add_f32_dpp v53, v53, v53 row_ror:4 row_mask:0xf bank_mask:0xf
    s_nop 0
    v_add_f32_dpp v52, v52, v52 row_ror:2 row_mask:0xf bank_mask:0xf
    v_add_f32_dpp v53, v53, v53 row_ror:2 row_mask:0xf bank_mask:0xf
    s_nop 0
    v_add_f32_dpp v52, v52, v52 row_ror:1 row_mask:0xf bank_mask:0xf
    v_add_f32_dpp v53, v53, v53 row_ror:1 row_mask:0xf bank_mask:0xf
    v_mov_b32 v50, v52
    v_mov_b32 v51, v53
    s_nop 0
    v_permlane16_swap_b32 v52, v50
    v_permlane16_swap_b32 v53, v51
    v_add_f32 v52, v52, v50
    v_add_f32 v53, v53, v51
    v_mov_b32 v50, v52
    v_mov_b32 v51, v53
    s_nop 0
    v_permlane32_swap_b32 v52, v50
    v_permlane32_swap_b32 v53, v51
    v_add_f32 v52, v52, v50
    v_add_f32 v53, v53, v51
    v_mul_f32 v52, s51, v52
    v_mul_f32 v53, s51, v53
    v_cvt_pk_bf16_f32 v50, v48, v52
    v_cvt_pk_bf16_f32 v51, v49, v53
    v_lshlrev_b32 v48, 16, v50
    v_lshlrev_b32 v49, 16, v51
    v_and_b32 v52, 0xffff0000, v50
    v_and_b32 v53, 0xffff0000, v51
    v_add_f32 v52, s50, v52
    v_add_f32 v53, s50, v53
    v_cvt_pk_bf16_f32 v50, v52, v53
    v_lshlrev_b32 v52, 16, v50
    v_and_b32 v53, 0xffff0000, v50
    v_sqrt_f32 v56, v52
    v_sqrt_f32 v57, v53
    v_rcp_f32 v54, v56
    v_rcp_f32 v55, v57
    v_fma_f32 v50, -v56, v56, v52
    v_fma_f32 v51, -v57, v57, v53
    v_mul_f32 v54, 0.5, v54
    v_mul_f32 v55, 0.5, v55
    v_fma_f32 v56, v50, v54, v56
    v_fma_f32 v57, v51, v55, v57
    v_cvt_pk_bf16_f32 v50, v56, v57
    v_lshlrev_b32 v56, 16, v50
    v_and_b32 v57, 0xffff0000, v50
    v_rcp_f32 v54, v56
    v_rcp_f32 v55, v57
    v_fma_f32 v50, -v56, v54, 1.0
    v_fma_f32 v51, -v57, v55, 1.0
    v_fma_f32 v54, v50, v54, v54
    v_fma_f32 v55, v51, v55, v55
    v_sub_f32 v32, v32, v48
    v_sub_f32 v36, v36, v48
    v_sub_f32 v40, v40, v49
    v_sub_f32 v44, v44, v49
    v_sub_f32 v33, v33, v48
    v_sub_f32 v37, v37, v48
    v_sub_f32 v41, v41, v49
    v_sub_f32 v45, v45, v49
    v_cvt_pk_bf16_f32 v58, v32, v33
    v_cvt_pk_bf16_f32 v60, v36, v37
    v_cvt_pk_bf16_f32 v62, v40, v41
    v_cvt_pk_bf16_f32 v64, v44, v45
    v_lshlrev_b32 v32, 16, v58
    v_lshlrev_b32 v36, 16, v60
    v_lshlrev_b32 v40, 16, v62
    v_lshlrev_b32 v44, 16, v64
    v_and_b32 v33, 0xffff0000, v58
    v_and_b32 v37, 0xffff0000, v60
    v_and_b32 v41, 0xffff0000, v62
    v_and_b32 v45, 0xffff0000, v64
    v_mul_f32 v58, v32, v54
    v_mul_f32 v60, v36, v54
    v_mul_f32 v62, v40, v55
    v_mul_f32 v64, v44, v55
    v_mul_f32 v59, v33, v54
    v_mul_f32 v61, v37, v54
    v_mul_f32 v63, v41, v55
    v_mul_f32 v65, v45, v55
    v_fma_f32 v32, -v58, v56, v32
    v_fma_f32 v36, -v60, v56, v36
    v_fma_f32 v40, -v62, v57, v40
    v_fma_f32 v44, -v64, v57, v44
    v_fma_f32 v33, -v59, v56, v33
    v_fma_f32 v37, -v61, v56, v37
    v_fma_f32 v41, -v63, v57, v41
    v_fma_f32 v45, -v65, v57, v45
    v_fma_f32 v32, v32, v54, v58
    v_fma_f32 v36, v36, v54, v60
    v_fma_f32 v40, v40, v55, v62
    v_fma_f32 v44, v44, v55, v64
    v_fma_f32 v33, v33, v54, v59
    v_fma_f32 v37, v37, v54, v61
    v_fma_f32 v41, v41, v55, v63
    v_fma_f32 v45, v45, v55, v65
    v_cvt_pk_bf16_f32 v58, v32, v33
    v_cvt_pk_bf16_f32 v60, v36, v37
    v_cvt_pk_bf16_f32 v62, v40, v41
    v_cvt_pk_bf16_f32 v64, v44, v45
    v_lshlrev_b32 v32, 16, v58
    v_lshlrev_b32 v36, 16, v60
    v_lshlrev_b32 v40, 16, v62
    v_lshlrev_b32 v44, 16, v64
    v_and_b32 v33, 0xffff0000, v58
    v_and_b32 v37, 0xffff0000, v60
    v_and_b32 v41, 0xffff0000, v62
    v_and_b32 v45, 0xffff0000, v64
    v_sub_f32 v34, v34, v48
    v_sub_f32 v38, v38, v48
    v_sub_f32 v42, v42, v49
    v_sub_f32 v46, v46, v49
    v_sub_f32 v35, v35, v48
    v_sub_f32 v39, v39, v48
    v_sub_f32 v43, v43, v49
    v_sub_f32 v47, v47, v49
    v_cvt_pk_bf16_f32 v58, v34, v35
    v_cvt_pk_bf16_f32 v60, v38, v39
    v_cvt_pk_bf16_f32 v62, v42, v43
    v_cvt_pk_bf16_f32 v64, v46, v47
    v_lshlrev_b32 v34, 16, v58
    v_lshlrev_b32 v38, 16, v60
    v_lshlrev_b32 v42, 16, v62
    v_lshlrev_b32 v46, 16, v64
    v_and_b32 v35, 0xffff0000, v58
    v_and_b32 v39, 0xffff0000, v60
    v_and_b32 v43, 0xffff0000, v62
    v_and_b32 v47, 0xffff0000, v64
    v_mul_f32 v58, v34, v54
    v_mul_f32 v60, v38, v54
    v_mul_f32 v62, v42, v55
    v_mul_f32 v64, v46, v55
    v_mul_f32 v59, v35, v54
    v_mul_f32 v61, v39, v54
    v_mul_f32 v63, v43, v55
    v_mul_f32 v65, v47, v55
    v_fma_f32 v34, -v58, v56, v34
    v_fma_f32 v38, -v60, v56, v38
    v_fma_f32 v42, -v62, v57, v42
    v_fma_f32 v46, -v64, v57, v46
    v_fma_f32 v35, -v59, v56, v35
    v_fma_f32 v39, -v61, v56, v39
    v_fma_f32 v43, -v63, v57, v43
    v_fma_f32 v47, -v65, v57, v47
    v_fma_f32 v34, v34, v54, v58
    v_fma_f32 v38, v38, v54, v60
    v_fma_f32 v42, v42, v55, v62
    v_fma_f32 v46, v46, v55, v64
    v_fma_f32 v35, v35, v54, v59
    v_fma_f32 v39, v39, v54, v61
    v_fma_f32 v43, v43, v55, v63
    v_fma_f32 v47, v47, v55, v65
    v_cvt_pk_bf16_f32 v58, v34, v35
    v_cvt_pk_bf16_f32 v60, v38, v39
    v_cvt_pk_bf16_f32 v62, v42, v43
    v_cvt_pk_bf16_f32 v64, v46, v47
    v_lshlrev_b32 v34, 16, v58
    v_lshlrev_b32 v38, 16, v60
    v_lshlrev_b32 v42, 16, v62
    v_lshlrev_b32 v46, 16, v64
    v_and_b32 v35, 0xffff0000, v58
    v_and_b32 v39, 0xffff0000, v60
    v_and_b32 v43, 0xffff0000, v62
    v_and_b32 v47, 0xffff0000, v64
    v_add_f32 v48, v32, v33
    v_add_f32 v50, v34, v35
    v_add_f32 v52, v36, v37
    v_add_f32 v54, v38, v39
    v_add_f32 v49, v40, v41
    v_add_f32 v51, v42, v43
    v_add_f32 v53, v44, v45
    v_add_f32 v55, v46, v47
    v_add_f32 v48, v48, v50
    v_add_f32 v52, v52, v54
    v_add_f32 v49, v49, v51
    v_add_f32 v53, v53, v55
    v_add_f32 v48, v48, v52
    v_add_f32 v49, v49, v53
    s_nop 0
    v_add_f32_dpp v48, v48, v48 row_ror:8 row_mask:0xf bank_mask:0xf
    v_add_f32_dpp v49, v49, v49 row_ror:8 row_mask:0xf bank_mask:0xf
    s_nop 0
    v_add_f32_dpp v48, v48, v48 row_ror:4 row_mask:0xf bank_mask:0xf
    v_add_f32_dpp v49, v49, v49 row_ror:4 row_mask:0xf bank_mask:0xf
    s_nop 0
    v_add_f32_dpp v48, v48, v48 row_ror:2 row_mask:0xf bank_mask:0xf
    v_add_f32_dpp v49, v49, v49 row_ror:2 row_mask:0xf bank_mask:0xf
    s_nop 0
    v_add_f32_dpp v48, v48, v48 row_ror:1 row_mask:0xf bank_mask:0xf
    v_add_f32_dpp v49, v49, v49 row_ror:1 row_mask:0xf bank_mask:0xf
    v_mov_b32 v50, v48
    v_mov_b32 v51, v49
    s_nop 0
    v_permlane16_swap_b32 v48, v50
    v_permlane16_swap_b32 v49, v51
    v_add_f32 v48, v48, v50
    v_add_f32 v49, v49, v51
    v_mov_b32 v50, v48
    v_mov_b32 v51, v49
    s_nop 0
    v_permlane32_swap_b32 v48, v50
    v_permlane32_swap_b32 v49, v51
    v_add_f32 v48, v48, v50
    v_add_f32 v49, v49, v51
    v_mul_f32 v48, s51, v48
    v_mul_f32 v49, s51, v49
    v_sub_f32 v50, v32, v48
    v_sub_f32 v54, v36, v48
    v_sub_f32 v51, v40, v49
    v_sub_f32 v55, v44, v49
    v_mul_f32 v52, v50, v50
    v_mul_f32 v56, v54, v54
    v_mul_f32 v53, v51, v51
    v_mul_f32 v57, v55, v55
    v_sub_f32 v50, v33, v48
    v_sub_f32 v54, v37, v48
    v_sub_f32 v51, v41, v49
    v_sub_f32 v55, v45, v49
    v_fmac_f32 v52, v50, v50
    v_fmac_f32 v56, v54, v54
    v_fmac_f32 v53, v51, v51
    v_fmac_f32 v57, v55, v55
    v_sub_f32 v50, v34, v48
    v_sub_f32 v54, v38, v48
    v_sub_f32 v51, v42, v49
    v_sub_f32 v55, v46, v49
    v_fmac_f32 v52, v50, v50
    v_fmac_f32 v56, v54, v54
    v_fmac_f32 v53, v51, v51
    v_fmac_f32 v57, v55, v55
    v_sub_f32 v50, v35, v48
    v_sub_f32 v54, v39, v48
    v_sub_f32 v51, v43, v49
    v_sub_f32 v55, v47, v49
    v_fmac_f32 v52, v50, v50
    v_fmac_f32 v56, v54, v54
    v_fmac_f32 v53, v51, v51
    v_fmac_f32 v57, v55, v55
    v_add_f32 v52, v52, v56
    v_add_f32 v53, v53, v57
    s_nop 0
    v_add_f32_dpp v52, v52, v52 row_ror:8 row_mask:0xf bank_mask:0xf
    v_add_f32_dpp v53, v53, v53 row_ror:8 row_mask:0xf bank_mask:0xf
    s_nop 0
    v_add_f32_dpp v52, v52, v52 row_ror:4 row_mask:0xf bank_mask:0xf
    v_add_f32_dpp v53, v53, v53 row_ror:4 row_mask:0xf bank_mask:0xf
    s_nop 0
    v_add_f32_dpp v52, v52, v52 row_ror:2 row_mask:0xf bank_mask:0xf
    v_add_f32_dpp v53, v53, v53 row_ror:2 row_mask:0xf bank_mask:0xf
    s_nop 0
    v_add_f32_dpp v52, v52, v52 row_ror:1 row_mask:0xf bank_mask:0xf
    v_add_f32_dpp v53, v53, v53 row_ror:1 row_mask:0xf bank_mask:0xf
    v_mov_b32 v50, v52
    v_mov_b32 v51, v53
    s_nop 0
    v_permlane16_swap_b32 v52, v50
    v_permlane16_swap_b32 v53, v51
    v_add_f32 v52, v52, v50
    v_add_f32 v53, v53, v51
    v_mov_b32 v50, v52
    v_mov_b32 v51, v53
    s_nop 0
    v_permlane32_swap_b32 v52, v50
    v_permlane32_swap_b32 v53, v51
    v_add_f32 v52, v52, v50
    v_add_f32 v53, v53, v51
    v_mul_f32 v52, s51, v52
    v_mul_f32 v53, s51, v53
    v_cvt_pk_bf16_f32 v50, v48, v52
    v_cvt_pk_bf16_f32 v51, v49, v53
    v_lshlrev_b32 v48, 16, v50
    v_lshlrev_b32 v49, 16, v51
    v_and_b32 v52, 0xffff0000, v50
    v_and_b32 v53, 0xffff0000, v51
    v_add_f32 v52, s50, v52
    v_add_f32 v53, s50, v53
    v_cvt_pk_bf16_f32 v50, v52, v53
    v_lshlrev_b32 v52, 16, v50
    v_and_b32 v53, 0xffff0000, v50
    v_sqrt_f32 v56, v52
    v_sqrt_f32 v57, v53
    v_rcp_f32 v54, v56
    v_rcp_f32 v55, v57
    v_fma_f32 v50, -v56, v56, v52
    v_fma_f32 v51, -v57, v57, v53
    v_mul_f32 v54, 0.5, v54
    v_mul_f32 v55, 0.5, v55
    v_fma_f32 v56, v50, v54, v56
    v_fma_f32 v57, v51, v55, v57
    v_cvt_pk_bf16_f32 v50, v56, v57
    v_lshlrev_b32 v56, 16, v50
    v_and_b32 v57, 0xffff0000, v50
    v_rcp_f32 v54, v56
    v_rcp_f32 v55, v57
    v_fma_f32 v50, -v56, v54, 1.0
    v_fma_f32 v51, -v57, v55, 1.0
    v_fma_f32 v54, v50, v54, v54
    v_fma_f32 v55, v51, v55, v55
    v_sub_f32 v32, v32, v48
    v_sub_f32 v36, v36, v48
    v_sub_f32 v40, v40, v49
    v_sub_f32 v44, v44, v49
    v_sub_f32 v33, v33, v48
    v_sub_f32 v37, v37, v48
    v_sub_f32 v41, v41, v49
    v_sub_f32 v45, v45, v49
    v_cvt_pk_bf16_f32 v58, v32, v33
    v_cvt_pk_bf16_f32 v60, v36, v37
    v_cvt_pk_bf16_f32 v62, v40, v41
    v_cvt_pk_bf16_f32 v64, v44, v45
    v_lshlrev_b32 v32, 16, v58
    v_lshlrev_b32 v36, 16, v60
    v_lshlrev_b32 v40, 16, v62
    v_lshlrev_b32 v44, 16, v64
    v_and_b32 v33, 0xffff0000, v58
    v_and_b32 v37, 0xffff0000, v60
    v_and_b32 v41, 0xffff0000, v62
    v_and_b32 v45, 0xffff0000, v64
    v_mul_f32 v58, v32, v54
    v_mul_f32 v60, v36, v54
    v_mul_f32 v62, v40, v55
    v_mul_f32 v64, v44, v55
    v_mul_f32 v59, v33, v54
    v_mul_f32 v61, v37, v54
    v_mul_f32 v63, v41, v55
    v_mul_f32 v65, v45, v55
    v_fma_f32 v32, -v58, v56, v32
    v_fma_f32 v36, -v60, v56, v36
    v_fma_f32 v40, -v62, v57, v40
    v_fma_f32 v44, -v64, v57, v44
    v_fma_f32 v33, -v59, v56, v33
    v_fma_f32 v37, -v61, v56, v37
    v_fma_f32 v41, -v63, v57, v41
    v_fma_f32 v45, -v65, v57, v45
    v_fma_f32 v32, v32, v54, v58
    v_fma_f32 v36, v36, v54, v60
    v_fma_f32 v40, v40, v55, v62
    v_fma_f32 v44, v44, v55, v64
    v_fma_f32 v33, v33, v54, v59
    v_fma_f32 v37, v37, v54, v61
    v_fma_f32 v41, v41, v55, v63
    v_fma_f32 v45, v45, v55, v65
    v_cvt_pk_bf16_f32 v58, v32, v33
    v_cvt_pk_bf16_f32 v60, v36, v37
    v_cvt_pk_bf16_f32 v62, v40, v41
    v_cvt_pk_bf16_f32 v64, v44, v45
    v_lshlrev_b32 v32, 16, v58
    v_lshlrev_b32 v36, 16, v60
    v_lshlrev_b32 v40, 16, v62
    v_lshlrev_b32 v44, 16, v64
    v_and_b32 v33, 0xffff0000, v58
    v_and_b32 v37, 0xffff0000, v60
    v_and_b32 v41, 0xffff0000, v62
    v_and_b32 v45, 0xffff0000, v64
    v_sub_f32 v34, v34, v48
    v_sub_f32 v38, v38, v48
    v_sub_f32 v42, v42, v49
    v_sub_f32 v46, v46, v49
    v_sub_f32 v35, v35, v48
    v_sub_f32 v39, v39, v48
    v_sub_f32 v43, v43, v49
    v_sub_f32 v47, v47, v49
    v_cvt_pk_bf16_f32 v58, v34, v35
    v_cvt_pk_bf16_f32 v60, v38, v39
    v_cvt_pk_bf16_f32 v62, v42, v43
    v_cvt_pk_bf16_f32 v64, v46, v47
    v_lshlrev_b32 v34, 16, v58
    v_lshlrev_b32 v38, 16, v60
    v_lshlrev_b32 v42, 16, v62
    v_lshlrev_b32 v46, 16, v64
    v_and_b32 v35, 0xffff0000, v58
    v_and_b32 v39, 0xffff0000, v60
    v_and_b32 v43, 0xffff0000, v62
    v_and_b32 v47, 0xffff0000, v64
    v_mul_f32 v58, v34, v54
    v_mul_f32 v60, v38, v54
    v_mul_f32 v62, v42, v55
    v_mul_f32 v64, v46, v55
    v_mul_f32 v59, v35, v54
    v_mul_f32 v61, v39, v54
    v_mul_f32 v63, v43, v55
    v_mul_f32 v65, v47, v55
    v_fma_f32 v34, -v58, v56, v34
    v_fma_f32 v38, -v60, v56, v38
    v_fma_f32 v42, -v62, v57, v42
    v_fma_f32 v46, -v64, v57, v46
    v_fma_f32 v35, -v59, v56, v35
    v_fma_f32 v39, -v61, v56, v39
    v_fma_f32 v43, -v63, v57, v43
    v_fma_f32 v47, -v65, v57, v47
    v_fma_f32 v34, v34, v54, v58
    v_fma_f32 v38, v38, v54, v60
    v_fma_f32 v42, v42, v55, v62
    v_fma_f32 v46, v46, v55, v64
    v_fma_f32 v35, v35, v54, v59
    v_fma_f32 v39, v39, v54, v61
    v_fma_f32 v43, v43, v55, v63
    v_fma_f32 v47, v47, v55, v65
    v_cvt_pk_bf16_f32 v58, v34, v35
    v_cvt_pk_bf16_f32 v60, v38, v39
    v_cvt_pk_bf16_f32 v62, v42, v43
    v_cvt_pk_bf16_f32 v64, v46, v47
    v_lshlrev_b32 v34, 16, v58
    v_lshlrev_b32 v38, 16, v60
    v_lshlrev_b32 v42, 16, v62
    v_lshlrev_b32 v46, 16, v64
    v_and_b32 v35, 0xffff0000, v58
    v_and_b32 v39, 0xffff0000, v60
    v_and_b32 v43, 0xffff0000, v62
    v_and_b32 v47, 0xffff0000, v64
    v_cvt_pk_bf16_f32 v72, v32, v33
    v_cvt_pk_bf16_f32 v73, v34, v35
    v_cvt_pk_bf16_f32 v74, v36, v37
    v_cvt_pk_bf16_f32 v75, v38, v39
    v_cvt_pk_bf16_f32 v76, v40, v41
    v_cvt_pk_bf16_f32 v77, v42, v43
    v_cvt_pk_bf16_f32 v78, v44, v45
    v_cvt_pk_bf16_f32 v79, v46, v47
    buffer_store_dwordx4 v[72:75], v3, s[28:31], 0 offen offset:0
    buffer_store_dwordx4 v[76:79], v3, s[28:31], 0 offen offset:1024
K3_END:
    s_endpgm
.globl k4_kernel
.p2align 8
.type k4_kernel,@function
k4_kernel:
    s_cmp_ge_u32 s2, 240
    s_cbranch_scc1 k4_kernel_END
    s_load_dwordx4 s[12:15], s[0:1], 104
    s_load_dwordx2 s[36:37], s[0:1], 0
    s_load_dwordx4 s[4:7], s[0:1], 72
    s_load_dwordx4 s[8:11], s[0:1], 88
    s_and_b32 s40, s2, 15
    s_lshr_b32 s41, s2, 4
    v_and_b32 v1, 63, v0
    v_lshrrev_b32 v2, 6, v0
    v_and_b32 v5, 15, v0
    v_bfe_u32 v6, v0, 4, 2
    v_lshrrev_b32 v7, 8, v0
    v_bfe_u32 v8, v0, 6, 2
    s_nop 0
    s_nop 0
    v_readfirstlane_b32 s60, v2
    s_waitcnt lgkmcnt(0)
    s_mov_b32 s16, s14
    s_mov_b32 s17, s15
    s_mov_b32 s18, 0x1460000
    s_mov_b32 s19, 0x00020000
    s_lshl_b32 s60, s60, 10
    v_lshrrev_b32 v3, 3, v1
    v_and_b32 v4, 7, v1
    s_mul_i32 s42, s41, 96
    s_mul_i32 s43, s40, 128
    s_mov_b32 s46, 1024
    s_mov_b32 s47, 1024
    s_mov_b32 s48, 0xb00000
    s_mov_b32 s49, 0x900000
    v_add_u32 v9, 0, v2
    v_subrev_u32 v10, 28, v9
    v_cmp_gt_u32 vcc, 28, v9
    s_nop 1
    v_cndmask_b32 v9, v10, v9, vcc
    v_mul_u32_u24 v10, 8, v9
    v_add_u32 v10, v10, v3
    v_and_b32 v11, 7, v10
    v_xor_b32 v11, v11, v4
    v_add_u32 v12, s42, v10
    v_mul_lo_u32 v12, v12, s46
    v_add_u32 v12, s48, v12
    v_subrev_u32 v13, 96, v10
    v_add_u32 v13, s43, v13
    v_mul_lo_u32 v13, v13, s47
    v_add_u32 v13, s49, v13
    v_cmp_gt_u32 s[50:51], 12, v9
    s_nop 1
    v_cndmask_b32 v12, v13, v12, s[50:51]
    v_lshl_add_u32 v88, v11, 4, v12
    v_add_u32 v9, 8, v2
    v_subrev_u32 v10, 28, v9
    v_cmp_gt_u32 vcc, 28, v9
    s_nop 1
    v_cndmask_b32 v9, v10, v9, vcc
    v_mul_u32_u24 v10, 8, v9
    v_add_u32 v10, v10, v3
    v_and_b32 v11, 7, v10
    v_xor_b32 v11, v11, v4
    v_add_u32 v12, s42, v10
    v_mul_lo_u32 v12, v12, s46
    v_add_u32 v12, s48, v12
    v_subrev_u32 v13, 96, v10
    v_add_u32 v13, s43, v13
    v_mul_lo_u32 v13, v13, s47
    v_add_u32 v13, s49, v13
    v_cmp_gt_u32 s[50:51], 12, v9
    s_nop 1
    v_cndmask_b32 v12, v13, v12, s[50:51]
    v_lshl_add_u32 v89, v11, 4, v12
    v_add_u32 v9, 16, v2
    v_subrev_u32 v10, 28, v9
    v_cmp_gt_u32 vcc, 28, v9
    s_nop 1
    v_cndmask_b32 v9, v10, v9, vcc
    v_mul_u32_u24 v10, 8, v9
    v_add_u32 v10, v10, v3
    v_and_b32 v11, 7, v10
    v_xor_b32 v11, v11, v4
    v_add_u32 v12, s42, v10
    v_mul_lo_u32 v12, v12, s46
    v_add_u32 v12, s48, v12
    v_subrev_u32 v13, 96, v10
    v_add_u32 v13, s43, v13
    v_mul_lo_u32 v13, v13, s47
    v_add_u32 v13, s49, v13
    v_cmp_gt_u32 s[50:51], 12, v9
    s_nop 1
    v_cndmask_b32 v12, v13, v12, s[50:51]
    v_lshl_add_u32 v90, v11, 4, v12
    v_add_u32 v9, 24, v2
    v_subrev_u32 v10, 28, v9
    v_cmp_gt_u32 vcc, 28, v9
    s_nop 1
    v_cndmask_b32 v9, v10, v9, vcc
    v_mul_u32_u24 v10, 8, v9
    v_add_u32 v10, v10, v3
    v_and_b32 v11, 7, v10
    v_xor_b32 v11, v11, v4
    v_add_u32 v12, s42, v10
    v_mul_lo_u32 v12, v12, s46
    v_add_u32 v12, s48, v12
    v_subrev_u32 v13, 96, v10
    v_add_u32 v13, s43, v13
    v_mul_lo_u32 v13, v13, s47
    v_add_u32 v13, s49, v13
    v_cmp_gt_u32 s[50:51], 12, v9
    s_nop 1
    v_cndmask_b32 v12, v13, v12, s[50:51]
    v_lshl_add_u32 v91, v11, 4, v12
    s_add_u32 s64, s60, 0
    s_cmp_ge_u32 s64, 28672
    s_cselect_b32 s52, 28672, 0
    s_sub_u32 s64, s64, s52
    s_add_u32 s65, s60, 8192
    s_cmp_ge_u32 s65, 28672
    s_cselect_b32 s52, 28672, 0
    s_sub_u32 s65, s65, s52
    s_add_u32 s66, s60, 16384
    s_cmp_ge_u32 s66, 28672
    s_cselect_b32 s52, 28672, 0
    s_sub_u32 s66, s66, s52
    s_add_u32 s67, s60, 24576
    s_cmp_ge_u32 s67, 28672
    s_cselect_b32 s52, 28672, 0
    s_sub_u32 s67, s67, s52
    s_cmp_lt_u32 s60, 4096
    s_cselect_b32 s54, -1, 0
    s_mov_b32 s55, s54
    s_add_u32 m0, s64, 0
    s_mov_b32 s44, 0
    buffer_load_dwordx4 v88, s[16:19], s44 offen lds
    s_add_u32 m0, s65, 0
    s_mov_b32 s44, 0
    buffer_load_dwordx4 v89, s[16:19], s44 offen lds
    s_add_u32 m0, s66, 0
    s_mov_b32 s44, 0
    buffer_load_dwordx4 v90, s[16:19], s44 offen lds
    s_add_u32 m0, s67, 0
    s_mov_b32 s44, 0
    s_mov_b64 exec, s[54:55]
    buffer_load_dwordx4 v91, s[16:19], s44 offen lds
    s_mov_b64 exec, -1
    v_and_b32 v9, 7, v5
    v_xor_b32 v9, v9, v6
    v_xor_b32 v9, 0, v9
    v_lshlrev_b32 v9, 4, v9
    v_mul_u32_u24 v10, 48, v7
    v_add_u32 v10, v10, v5
    v_mul_u32_u24 v10, 128, v10
    v_add_u32 v96, v9, v10
    v_mul_u32_u24 v10, 32, v8
    v_add_u32 v10, v10, v5
    v_mul_u32_u24 v10, 128, v10
    v_add_u32 v10, v9, v10
    v_add_u32 v98, 12288, v10
    v_add_u32 v100, 0x10000, v96
    v_add_u32 v102, 0x10000, v98
    v_add_u32 v104, 0x20000, v96
    v_add_u32 v106, 0x20000, v98
    v_and_b32 v9, 7, v5
    v_xor_b32 v9, v9, v6
    v_xor_b32 v9, 4, v9
    v_lshlrev_b32 v9, 4, v9
    v_mul_u32_u24 v10, 48, v7
    v_add_u32 v10, v10, v5
    v_mul_u32_u24 v10, 128, v10
    v_add_u32 v97, v9, v10
    v_mul_u32_u24 v10, 32, v8
    v_add_u32 v10, v10, v5
    v_mul_u32_u24 v10, 128, v10
    v_add_u32 v10, v9, v10
    v_add_u32 v99, 12288, v10
    v_add_u32 v101, 0x10000, v97
    v_add_u32 v103, 0x10000, v99
    v_add_u32 v105, 0x20000, v97
    v_add_u32 v107, 0x20000, v99
    v_mov_b32 v24, 0
    v_mov_b32 v25, 0
    v_mov_b32 v26, 0
    v_mov_b32 v27, 0
    v_mov_b32 v28, 0
    v_mov_b32 v29, 0
    v_mov_b32 v30, 0
    v_mov_b32 v31, 0
    v_mov_b32 v32, 0
    v_mov_b32 v33, 0
    v_mov_b32 v34, 0
    v_mov_b32 v35, 0
    v_mov_b32 v36, 0
    v_mov_b32 v37, 0
    v_mov_b32 v38, 0
    v_mov_b32 v39, 0
    v_mov_b32 v40, 0
    v_mov_b32 v41, 0
    v_mov_b32 v42, 0
    v_mov_b32 v43, 0
    v_mov_b32 v44, 0
    v_mov_b32 v45, 0
    v_mov_b32 v46, 0
    v_mov_b32 v47, 0
    s_mov_b32 s24, s4
    s_mov_b32 s25, s5
    s_mov_b32 s26, 0xac0
    s_mov_b32 s27, 0x00020000
    s_add_u32 s28, s14, 0xf00000
    s_addc_u32 s29, s15, 0
    s_mov_b32 s30, 0x560000
    s_mov_b32 s31, 0x00020000
    s_mul_i32 s42, s41, 96
    v_mul_u32_u24 v9, 48, v7
    v_lshl_add_u32 v9, v6, 2, v9
    v_add_u32 v9, s42, v9
    s_mul_i32 s42, s40, 128
    v_mul_u32_u24 v10, 32, v8
    v_add_u32 v10, v10, v5
    v_add_u32 v10, s42, v10
    s_mov_b32 s43, 2752
    v_mul_lo_u32 v10, v10, s43
    v_lshlrev_b32 v11, 1, v9
    v_add_u32 v10, v10, v11
    s_mov_b32 s45, 0x3d372713
    s_mov_b32 s46, 0xc0135761
    buffer_load_dwordx2 v[128:129], v11, s[24:27], 0 offen offset:0
    buffer_load_dwordx2 v[130:131], v11, s[24:27], 0 offen offset:32
    buffer_load_dwordx2 v[132:133], v11, s[24:27], 0 offen offset:64
    s_add_u32 m0, s64, 28672
    s_mov_b32 s44, 128
    buffer_load_dwordx4 v88, s[16:19], s44 offen lds
    s_add_u32 m0, s65, 28672
    s_mov_b32 s44, 128
    buffer_load_dwordx4 v89, s[16:19], s44 offen lds
    s_add_u32 m0, s66, 28672
    s_mov_b32 s44, 128
    buffer_load_dwordx4 v90, s[16:19], s44 offen lds
    s_add_u32 m0, s67, 28672
    s_mov_b32 s44, 128
    s_mov_b64 exec, s[54:55]
    buffer_load_dwordx4 v91, s[16:19], s44 offen lds
    s_mov_b64 exec, -1
    s_add_u32 m0, s64, 57344
    s_mov_b32 s44, 256
    buffer_load_dwordx4 v88, s[16:19], s44 offen lds
    s_add_u32 m0, s65, 57344
    s_mov_b32 s44, 256
    buffer_load_dwordx4 v89, s[16:19], s44 offen lds
    s_add_u32 m0, s66, 57344
    s_mov_b32 s44, 256
    buffer_load_dwordx4 v90, s[16:19], s44 offen lds
    s_add_u32 m0, s67, 57344
    s_mov_b32 s44, 256
    s_mov_b64 exec, s[54:55]
    buffer_load_dwordx4 v91, s[16:19], s44 offen lds
    s_mov_b64 exec, -1
    s_add_u32 m0, s64, 86016
    s_mov_b32 s44, 384
    buffer_load_dwordx4 v88, s[16:19], s44 offen lds
    s_add_u32 m0, s65, 86016
    s_mov_b32 s44, 384
    buffer_load_dwordx4 v89, s[16:19], s44 offen lds
    s_add_u32 m0, s66, 86016
    s_mov_b32 s44, 384
    buffer_load_dwordx4 v90, s[16:19], s44 offen lds
    s_add_u32 m0, s67, 86016
    s_mov_b32 s44, 384
    s_mov_b64 exec, s[54:55]
    buffer_load_dwordx4 v91, s[16:19], s44 offen lds
    s_mov_b64 exec, -1
    s_waitcnt vmcnt(15)
    s_barrier
    ds_read_b128 v[48:51], v96 offset:0
    ds_read_b128 v[52:55], v96 offset:2048
    ds_read_b128 v[56:59], v96 offset:4096
    ds_read_b128 v[60:63], v98 offset:0
    ds_read_b128 v[64:67], v98 offset:2048
    ds_read_b128 v[68:71], v97 offset:0
    ds_read_b128 v[72:75], v97 offset:2048
    ds_read_b128 v[76:79], v97 offset:4096
    ds_read_b128 v[80:83], v99 offset:0
    ds_read_b128 v[84:87], v99 offset:2048
    s_waitcnt lgkmcnt(5)
    v_mfma_f32_16x16x32_bf16 v[24:27], v[48:51], v[60:63], v[24:27]
    s_add_u32 m0, s64, 114688
    s_mov_b32 s44, 512
    buffer_load_dwordx4 v88, s[16:19], s44 offen lds
    v_mfma_f32_16x16x32_bf16 v[28:31], v[48:51], v[64:67], v[28:31]
    v_mfma_f32_16x16x32_bf16 v[32:35], v[52:55], v[60:63], v[32:35]
    v_mfma_f32_16x16x32_bf16 v[36:39], v[52:55], v[64:67], v[36:39]
    s_add_u32 m0, s65, 114688
    s_mov_b32 s44, 512
    buffer_load_dwordx4 v89, s[16:19], s44 offen lds
    v_mfma_f32_16x16x32_bf16 v[40:43], v[56:59], v[60:63], v[40:43]
    v_mfma_f32_16x16x32_bf16 v[44:47], v[56:59], v[64:67], v[44:47]
    s_waitcnt lgkmcnt(0)
    v_mfma_f32_16x16x32_bf16 v[24:27], v[68:71], v[80:83], v[24:27]
    s_add_u32 m0, s66, 114688
    s_mov_b32 s44, 512
    buffer_load_dwordx4 v90, s[16:19], s44 offen lds
    v_mfma_f32_16x16x32_bf16 v[28:31], v[68:71], v[84:87], v[28:31]
    v_mfma_f32_16x16x32_bf16 v[32:35], v[72:75], v[80:83], v[32:35]
    v_mfma_f32_16x16x32_bf16 v[36:39], v[72:75], v[84:87], v[36:39]
    s_add_u32 m0, s67, 114688
    s_mov_b32 s44, 512
    s_mov_b64 exec, s[54:55]
    buffer_load_dwordx4 v91, s[16:19], s44 offen lds
    s_mov_b64 exec, -1
    v_mfma_f32_16x16x32_bf16 v[40:43], v[76:79], v[80:83], v[40:43]
    v_mfma_f32_16x16x32_bf16 v[44:47], v[76:79], v[84:87], v[44:47]
    s_waitcnt vmcnt(12)
    s_barrier
    ds_read_b128 v[48:51], v96 offset:28672
    ds_read_b128 v[52:55], v96 offset:30720
    ds_read_b128 v[56:59], v96 offset:32768
    ds_read_b128 v[60:63], v98 offset:28672
    ds_read_b128 v[64:67], v98 offset:30720
    ds_read_b128 v[68:71], v97 offset:28672
    ds_read_b128 v[72:75], v97 offset:30720
    ds_read_b128 v[76:79], v97 offset:32768
    ds_read_b128 v[80:83], v99 offset:28672
    ds_read_b128 v[84:87], v99 offset:30720
    s_waitcnt lgkmcnt(5)
    v_mfma_f32_16x16x32_bf16 v[24:27], v[48:51], v[60:63], v[24:27]
    s_add_u32 m0, s64, 0
    s_mov_b32 s44, 640
    buffer_load_dwordx4 v88, s[16:19], s44 offen lds
    v_mfma_f32_16x16x32_bf16 v[28:31], v[48:51], v[64:67], v[28:31]
    v_mfma_f32_16x16x32_bf16 v[32:35], v[52:55], v[60:63], v[32:35]
    v_mfma_f32_16x16x32_bf16 v[36:39], v[52:55], v[64:67], v[36:39]
    s_add_u32 m0, s65, 0
    s_mov_b32 s44, 640
    buffer_load_dwordx4 v89, s[16:19], s44 offen lds
    v_mfma_f32_16x16x32_bf16 v[40:43], v[56:59], v[60:63], v[40:43]
    v_mfma_f32_16x16x32_bf16 v[44:47], v[56:59], v[64:67], v[44:47]
    s_waitcnt lgkmcnt(0)
    v_mfma_f32_16x16x32_bf16 v[24:27], v[68:71], v[80:83], v[24:27]
    s_add_u32 m0, s66, 0
    s_mov_b32 s44, 640
    buffer_load_dwordx4 v90, s[16:19], s44 offen lds
    v_mfma_f32_16x16x32_bf16 v[28:31], v[68:71], v[84:87], v[28:31]
    v_mfma_f32_16x16x32_bf16 v[32:35], v[72:75], v[80:83], v[32:35]
    v_mfma_f32_16x16x32_bf16 v[36:39], v[72:75], v[84:87], v[36:39]
    s_add_u32 m0, s67, 0
    s_mov_b32 s44, 640
    s_mov_b64 exec, s[54:55]
    buffer_load_dwordx4 v91, s[16:19], s44 offen lds
    s_mov_b64 exec, -1
    v_mfma_f32_16x16x32_bf16 v[40:43], v[76:79], v[80:83], v[40:43]
    v_mfma_f32_16x16x32_bf16 v[44:47], v[76:79], v[84:87], v[44:47]
    s_waitcnt vmcnt(12)
    s_barrier
    ds_read_b128 v[48:51], v96 offset:57344
    ds_read_b128 v[52:55], v96 offset:59392
    ds_read_b128 v[56:59], v96 offset:61440
    ds_read_b128 v[60:63], v98 offset:57344
    ds_read_b128 v[64:67], v98 offset:59392
    ds_read_b128 v[68:71], v97 offset:57344
    ds_read_b128 v[72:75], v97 offset:59392
    ds_read_b128 v[76:79], v97 offset:61440
    ds_read_b128 v[80:83], v99 offset:57344
    ds_read_b128 v[84:87], v99 offset:59392
    s_waitcnt lgkmcnt(5)
    v_mfma_f32_16x16x32_bf16 v[24:27], v[48:51], v[60:63], v[24:27]
    s_add_u32 m0, s64, 28672
    s_mov_b32 s44, 768
    buffer_load_dwordx4 v88, s[16:19], s44 offen lds
    v_mfma_f32_16x16x32_bf16 v[28:31], v[48:51], v[64:67], v[28:31]
    v_mfma_f32_16x16x32_bf16 v[32:35], v[52:55], v[60:63], v[32:35]
    v_mfma_f32_16x16x32_bf16 v[36:39], v[52:55], v[64:67], v[36:39]
    s_add_u32 m0, s65, 28672
    s_mov_b32 s44, 768
    buffer_load_dwordx4 v89, s[16:19], s44 offen lds
    v_mfma_f32_16x16x32_bf16 v[40:43], v[56:59], v[60:63], v[40:43]
    v_mfma_f32_16x16x32_bf16 v[44:47], v[56:59], v[64:67], v[44:47]
    s_waitcnt lgkmcnt(0)
    v_mfma_f32_16x16x32_bf16 v[24:27], v[68:71], v[80:83], v[24:27]
    s_add_u32 m0, s66, 28672
    s_mov_b32 s44, 768
    buffer_load_dwordx4 v90, s[16:19], s44 offen lds
    v_mfma_f32_16x16x32_bf16 v[28:31], v[68:71], v[84:87], v[28:31]
    v_mfma_f32_16x16x32_bf16 v[32:35], v[72:75], v[80:83], v[32:35]
    v_mfma_f32_16x16x32_bf16 v[36:39], v[72:75], v[84:87], v[36:39]
    s_add_u32 m0, s67, 28672
    s_mov_b32 s44, 768
    s_mov_b64 exec, s[54:55]
    buffer_load_dwordx4 v91, s[16:19], s44 offen lds
    s_mov_b64 exec, -1
    v_mfma_f32_16x16x32_bf16 v[40:43], v[76:79], v[80:83], v[40:43]
    v_mfma_f32_16x16x32_bf16 v[44:47], v[76:79], v[84:87], v[44:47]
    s_waitcnt vmcnt(12)
    s_barrier
    ds_read_b128 v[48:51], v100 offset:20480
    ds_read_b128 v[52:55], v100 offset:22528
    ds_read_b128 v[56:59], v100 offset:24576
    ds_read_b128 v[60:63], v102 offset:20480
    ds_read_b128 v[64:67], v102 offset:22528
    ds_read_b128 v[68:71], v101 offset:20480
    ds_read_b128 v[72:75], v101 offset:22528
    ds_read_b128 v[76:79], v101 offset:24576
    ds_read_b128 v[80:83], v103 offset:20480
    ds_read_b128 v[84:87], v103 offset:22528
    s_waitcnt lgkmcnt(5)
    v_mfma_f32_16x16x32_bf16 v[24:27], v[48:51], v[60:63], v[24:27]
    s_add_u32 m0, s64, 57344
    s_mov_b32 s44, 896
    buffer_load_dwordx4 v88, s[16:19], s44 offen lds
    v_mfma_f32_16x16x32_bf16 v[28:31], v[48:51], v[64:67], v[28:31]
    v_mfma_f32_16x16x32_bf16 v[32:35], v[52:55], v[60:63], v[32:35]
    v_mfma_f32_16x16x32_bf16 v[36:39], v[52:55], v[64:67], v[36:39]
    s_add_u32 m0, s65, 57344
    s_mov_b32 s44, 896
    buffer_load_dwordx4 v89, s[16:19], s44 offen lds
    v_mfma_f32_16x16x32_bf16 v[40:43], v[56:59], v[60:63], v[40:43]
    v_mfma_f32_16x16x32_bf16 v[44:47], v[56:59], v[64:67], v[44:47]
    s_waitcnt lgkmcnt(0)
    v_mfma_f32_16x16x32_bf16 v[24:27], v[68:71], v[80:83], v[24:27]
    s_add_u32 m0, s66, 57344
    s_mov_b32 s44, 896
    buffer_load_dwordx4 v90, s[16:19], s44 offen lds
    v_mfma_f32_16x16x32_bf16 v[28:31], v[68:71], v[84:87], v[28:31]
    v_mfma_f32_16x16x32_bf16 v[32:35], v[72:75], v[80:83], v[32:35]
    v_mfma_f32_16x16x32_bf16 v[36:39], v[72:75], v[84:87], v[36:39]
    s_add_u32 m0, s67, 57344
    s_mov_b32 s44, 896
    s_mov_b64 exec, s[54:55]
    buffer_load_dwordx4 v91, s[16:19], s44 offen lds
    s_mov_b64 exec, -1
    v_mfma_f32_16x16x32_bf16 v[40:43], v[76:79], v[80:83], v[40:43]
    v_mfma_f32_16x16x32_bf16 v[44:47], v[76:79], v[84:87], v[44:47]
    s_waitcnt vmcnt(12)
    s_barrier
    ds_read_b128 v[48:51], v100 offset:49152
    ds_read_b128 v[52:55], v100 offset:51200
    ds_read_b128 v[56:59], v100 offset:53248
    ds_read_b128 v[60:63], v102 offset:49152
    ds_read_b128 v[64:67], v102 offset:51200
    ds_read_b128 v[68:71], v101 offset:49152
    ds_read_b128 v[72:75], v101 offset:51200
    ds_read_b128 v[76:79], v101 offset:53248
    ds_read_b128 v[80:83], v103 offset:49152
    ds_read_b128 v[84:87], v103 offset:51200
    s_waitcnt lgkmcnt(5)
    v_mfma_f32_16x16x32_bf16 v[24:27], v[48:51], v[60:63], v[24:27]
    v_mfma_f32_16x16x32_bf16 v[28:31], v[48:51], v[64:67], v[28:31]
    v_mfma_f32_16x16x32_bf16 v[32:35], v[52:55], v[60:63], v[32:35]
    v_mfma_f32_16x16x32_bf16 v[36:39], v[52:55], v[64:67], v[36:39]
    v_mfma_f32_16x16x32_bf16 v[40:43], v[56:59], v[60:63], v[40:43]
    v_mfma_f32_16x16x32_bf16 v[44:47], v[56:59], v[64:67], v[44:47]
    s_waitcnt lgkmcnt(0)
    v_mfma_f32_16x16x32_bf16 v[24:27], v[68:71], v[80:83], v[24:27]
    v_mfma_f32_16x16x32_bf16 v[28:31], v[68:71], v[84:87], v[28:31]
    v_mfma_f32_16x16x32_bf16 v[32:35], v[72:75], v[80:83], v[32:35]
    v_mfma_f32_16x16x32_bf16 v[36:39], v[72:75], v[84:87], v[36:39]
    v_mfma_f32_16x16x32_bf16 v[40:43], v[76:79], v[80:83], v[40:43]
    v_mfma_f32_16x16x32_bf16 v[44:47], v[76:79], v[84:87], v[44:47]
    s_waitcnt vmcnt(8)
    s_barrier
    ds_read_b128 v[48:51], v96 offset:0
    ds_read_b128 v[52:55], v96 offset:2048
    ds_read_b128 v[56:59], v96 offset:4096
    ds_read_b128 v[60:63], v98 offset:0
    ds_read_b128 v[64:67], v98 offset:2048
    ds_read_b128 v[68:71], v97 offset:0
    ds_read_b128 v[72:75], v97 offset:2048
    ds_read_b128 v[76:79], v97 offset:4096
    ds_read_b128 v[80:83], v99 offset:0
    ds_read_b128 v[84:87], v99 offset:2048
    s_waitcnt lgkmcnt(5)
    v_mfma_f32_16x16x32_bf16 v[24:27], v[48:51], v[60:63], v[24:27]
    v_mfma_f32_16x16x32_bf16 v[28:31], v[48:51], v[64:67], v[28:31]
    v_mfma_f32_16x16x32_bf16 v[32:35], v[52:55], v[60:63], v[32:35]
    v_mfma_f32_16x16x32_bf16 v[36:39], v[52:55], v[64:67], v[36:39]
    v_mfma_f32_16x16x32_bf16 v[40:43], v[56:59], v[60:63], v[40:43]
    v_mfma_f32_16x16x32_bf16 v[44:47], v[56:59], v[64:67], v[44:47]
    s_waitcnt lgkmcnt(0)
    v_mfma_f32_16x16x32_bf16 v[24:27], v[68:71], v[80:83], v[24:27]
    v_mfma_f32_16x16x32_bf16 v[28:31], v[68:71], v[84:87], v[28:31]
    v_mfma_f32_16x16x32_bf16 v[32:35], v[72:75], v[80:83], v[32:35]
    v_mfma_f32_16x16x32_bf16 v[36:39], v[72:75], v[84:87], v[36:39]
    v_mfma_f32_16x16x32_bf16 v[40:43], v[76:79], v[80:83], v[40:43]
    v_mfma_f32_16x16x32_bf16 v[44:47], v[76:79], v[84:87], v[44:47]
    s_waitcnt vmcnt(4)
    s_barrier
    ds_read_b128 v[48:51], v96 offset:28672
    ds_read_b128 v[52:55], v96 offset:30720
    ds_read_b128 v[56:59], v96 offset:32768
    ds_read_b128 v[60:63], v98 offset:28672
    ds_read_b128 v[64:67], v98 offset:30720
    ds_read_b128 v[68:71], v97 offset:28672
    ds_read_b128 v[72:75], v97 offset:30720
    ds_read_b128 v[76:79], v97 offset:32768
    ds_read_b128 v[80:83], v99 offset:28672
    ds_read_b128 v[84:87], v99 offset:30720
    s_waitcnt lgkmcnt(5)
    v_mfma_f32_16x16x32_bf16 v[24:27], v[48:51], v[60:63], v[24:27]
    v_mfma_f32_16x16x32_bf16 v[28:31], v[48:51], v[64:67], v[28:31]
    v_mfma_f32_16x16x32_bf16 v[32:35], v[52:55], v[60:63], v[32:35]
    v_mfma_f32_16x16x32_bf16 v[36:39], v[52:55], v[64:67], v[36:39]
    v_mfma_f32_16x16x32_bf16 v[40:43], v[56:59], v[60:63], v[40:43]
    v_mfma_f32_16x16x32_bf16 v[44:47], v[56:59], v[64:67], v[44:47]
    s_waitcnt lgkmcnt(0)
    v_mfma_f32_16x16x32_bf16 v[24:27], v[68:71], v[80:83], v[24:27]
    v_mfma_f32_16x16x32_bf16 v[28:31], v[68:71], v[84:87], v[28:31]
    v_mfma_f32_16x16x32_bf16 v[32:35], v[72:75], v[80:83], v[32:35]
    v_mfma_f32_16x16x32_bf16 v[36:39], v[72:75], v[84:87], v[36:39]
    v_mfma_f32_16x16x32_bf16 v[40:43], v[76:79], v[80:83], v[40:43]
    v_mfma_f32_16x16x32_bf16 v[44:47], v[76:79], v[84:87], v[44:47]
    s_waitcnt vmcnt(0)
    s_barrier
    ds_read_b128 v[48:51], v96 offset:57344
    ds_read_b128 v[52:55], v96 offset:59392
    ds_read_b128 v[56:59], v96 offset:61440
    ds_read_b128 v[60:63], v98 offset:57344
    ds_read_b128 v[64:67], v98 offset:59392
    ds_read_b128 v[68:71], v97 offset:57344
    ds_read_b128 v[72:75], v97 offset:59392
    ds_read_b128 v[76:79], v97 offset:61440
    ds_read_b128 v[80:83], v99 offset:57344
    ds_read_b128 v[84:87], v99 offset:59392
    s_waitcnt lgkmcnt(5)
    v_mfma_f32_16x16x32_bf16 v[24:27], v[48:51], v[60:63], v[24:27]
    v_mfma_f32_16x16x32_bf16 v[28:31], v[48:51], v[64:67], v[28:31]
    v_mfma_f32_16x16x32_bf16 v[32:35], v[52:55], v[60:63], v[32:35]
    v_mfma_f32_16x16x32_bf16 v[36:39], v[52:55], v[64:67], v[36:39]
    v_mfma_f32_16x16x32_bf16 v[40:43], v[56:59], v[60:63], v[40:43]
    v_mfma_f32_16x16x32_bf16 v[44:47], v[56:59], v[64:67], v[44:47]
    s_waitcnt lgkmcnt(0)
    v_mfma_f32_16x16x32_bf16 v[24:27], v[68:71], v[80:83], v[24:27]
    v_mfma_f32_16x16x32_bf16 v[28:31], v[68:71], v[84:87], v[28:31]
    v_mfma_f32_16x16x32_bf16 v[32:35], v[72:75], v[80:83], v[32:35]
    v_mfma_f32_16x16x32_bf16 v[36:39], v[72:75], v[84:87], v[36:39]
    v_mfma_f32_16x16x32_bf16 v[40:43], v[76:79], v[80:83], v[40:43]
    v_mfma_f32_16x16x32_bf16 v[44:47], v[76:79], v[84:87], v[44:47]
    v_lshlrev_b32 v48, 16, v128
    v_and_b32 v49, 0xffff0000, v128
    v_lshlrev_b32 v50, 16, v129
    v_and_b32 v51, 0xffff0000, v129
    v_lshlrev_b32 v52, 16, v130
    v_and_b32 v53, 0xffff0000, v130
    v_lshlrev_b32 v54, 16, v131
    v_and_b32 v55, 0xffff0000, v131
    v_lshlrev_b32 v56, 16, v132
    v_and_b32 v57, 0xffff0000, v132
    v_lshlrev_b32 v58, 16, v133
    v_and_b32 v59, 0xffff0000, v133
    v_cvt_pk_bf16_f32 v60, v24, v25
    v_cvt_pk_bf16_f32 v62, v26, v27
    v_cvt_pk_bf16_f32 v64, v28, v29
    v_cvt_pk_bf16_f32 v66, v30, v31
    v_cvt_pk_bf16_f32 v68, v32, v33
    v_cvt_pk_bf16_f32 v70, v34, v35
    v_cvt_pk_bf16_f32 v72, v36, v37
    v_cvt_pk_bf16_f32 v74, v38, v39
    v_cvt_pk_bf16_f32 v76, v40, v41
    v_cvt_pk_bf16_f32 v78, v42, v43
    v_cvt_pk_bf16_f32 v80, v44, v45
    v_cvt_pk_bf16_f32 v82, v46, v47
    v_lshlrev_b32 v24, 16, v60
    v_lshlrev_b32 v26, 16, v62
    v_lshlrev_b32 v28, 16, v64
    v_lshlrev_b32 v30, 16, v66
    v_lshlrev_b32 v32, 16, v68
    v_lshlrev_b32 v34, 16, v70
    v_lshlrev_b32 v36, 16, v72
    v_lshlrev_b32 v38, 16, v74
    v_lshlrev_b32 v40, 16, v76
    v_lshlrev_b32 v42, 16, v78
    v_lshlrev_b32 v44, 16, v80
    v_lshlrev_b32 v46, 16, v82
    v_and_b32 v25, 0xffff0000, v60
    v_and_b32 v27, 0xffff0000, v62
    v_and_b32 v29, 0xffff0000, v64
    v_and_b32 v31, 0xffff0000, v66
    v_and_b32 v33, 0xffff0000, v68
    v_and_b32 v35, 0xffff0000, v70
    v_and_b32 v37, 0xffff0000, v72
    v_and_b32 v39, 0xffff0000, v74
    v_and_b32 v41, 0xffff0000, v76
    v_and_b32 v43, 0xffff0000, v78
    v_and_b32 v45, 0xffff0000, v80
    v_and_b32 v47, 0xffff0000, v82
    v_add_f32 v24, v24, v48
    v_add_f32 v26, v26, v50
    v_add_f32 v28, v28, v48
    v_add_f32 v30, v30, v50
    v_add_f32 v32, v32, v52
    v_add_f32 v34, v34, v54
    v_add_f32 v36, v36, v52
    v_add_f32 v38, v38, v54
    v_add_f32 v40, v40, v56
    v_add_f32 v42, v42, v58
    v_add_f32 v44, v44, v56
    v_add_f32 v46, v46, v58
    v_add_f32 v25, v25, v49
    v_add_f32 v27, v27, v51
    v_add_f32 v29, v29, v49
    v_add_f32 v31, v31, v51
    v_add_f32 v33, v33, v53
    v_add_f32 v35, v35, v55
    v_add_f32 v37, v37, v53
    v_add_f32 v39, v39, v55
    v_add_f32 v41, v41, v57
    v_add_f32 v43, v43, v59
    v_add_f32 v45, v45, v57
    v_add_f32 v47, v47, v59
    v_cvt_pk_bf16_f32 v60, v24, v25
    v_cvt_pk_bf16_f32 v62, v26, v27
    v_cvt_pk_bf16_f32 v64, v28, v29
    v_cvt_pk_bf16_f32 v66, v30, v31
    v_cvt_pk_bf16_f32 v68, v32, v33
    v_cvt_pk_bf16_f32 v70, v34, v35
    v_cvt_pk_bf16_f32 v72, v36, v37
    v_cvt_pk_bf16_f32 v74, v38, v39
    v_cvt_pk_bf16_f32 v76, v40, v41
    v_cvt_pk_bf16_f32 v78, v42, v43
    v_cvt_pk_bf16_f32 v80, v44, v45
    v_cvt_pk_bf16_f32 v82, v46, v47
    v_lshlrev_b32 v24, 16, v60
    v_lshlrev_b32 v26, 16, v62
    v_lshlrev_b32 v28, 16, v64
    v_lshlrev_b32 v30, 16, v66
    v_lshlrev_b32 v32, 16, v68
    v_lshlrev_b32 v34, 16, v70
    v_lshlrev_b32 v36, 16, v72
    v_lshlrev_b32 v38, 16, v74
    v_lshlrev_b32 v40, 16, v76
    v_lshlrev_b32 v42, 16, v78
    v_lshlrev_b32 v44, 16, v80
    v_lshlrev_b32 v46, 16, v82
    v_and_b32 v25, 0xffff0000, v60
    v_and_b32 v27, 0xffff0000, v62
    v_and_b32 v29, 0xffff0000, v64
    v_and_b32 v31, 0xffff0000, v66
    v_and_b32 v33, 0xffff0000, v68
    v_and_b32 v35, 0xffff0000, v70
    v_and_b32 v37, 0xffff0000, v72
    v_and_b32 v39, 0xffff0000, v74
    v_and_b32 v41, 0xffff0000, v76
    v_and_b32 v43, 0xffff0000, v78
    v_and_b32 v45, 0xffff0000, v80
    v_and_b32 v47, 0xffff0000, v82
    v_mul_f32 v60, v24, v24
    v_mul_f32 v62, v26, v26
    v_mul_f32 v64, v28, v28
    v_mul_f32 v66, v30, v30
    v_mul_f32 v68, v32, v32
    v_mul_f32 v70, v34, v34
    v_mul_f32 v72, v36, v36
    v_mul_f32 v74, v38, v38
    v_mul_f32 v76, v40, v40
    v_mul_f32 v78, v42, v42
    v_mul_f32 v80, v44, v44
    v_mul_f32 v82, v46, v46
    v_mul_f32 v61, v25, v25
    v_mul_f32 v63, v27, v27
    v_mul_f32 v65, v29, v29
    v_mul_f32 v67, v31, v31
    v_mul_f32 v69, v33, v33
    v_mul_f32 v71, v35, v35
    v_mul_f32 v73, v37, v37
    v_mul_f32 v75, v39, v39
    v_mul_f32 v77, v41, v41
    v_mul_f32 v79, v43, v43
    v_mul_f32 v81, v45, v45
    v_mul_f32 v83, v47, v47
    v_mul_f32 v60, s45, v60
    v_mul_f32 v62, s45, v62
    v_mul_f32 v64, s45, v64
    v_mul_f32 v66, s45, v66
    v_mul_f32 v68, s45, v68
    v_mul_f32 v70, s45, v70
    v_mul_f32 v72, s45, v72
    v_mul_f32 v74, s45, v74
    v_mul_f32 v76, s45, v76
    v_mul_f32 v78, s45, v78
    v_mul_f32 v80, s45, v80
    v_mul_f32 v82, s45, v82
    v_mul_f32 v61, s45, v61
    v_mul_f32 v63, s45, v63
    v_mul_f32 v65, s45, v65
    v_mul_f32 v67, s45, v67
    v_mul_f32 v69, s45, v69
    v_mul_f32 v71, s45, v71
    v_mul_f32 v73, s45, v73
    v_mul_f32 v75, s45, v75
    v_mul_f32 v77, s45, v77
    v_mul_f32 v79, s45, v79
    v_mul_f32 v81, s45, v81
    v_mul_f32 v83, s45, v83
    v_fma_f32 v60, v60, v24, v24
    v_fma_f32 v62, v62, v26, v26
    v_fma_f32 v64, v64, v28, v28
    v_fma_f32 v66, v66, v30, v30
    v_fma_f32 v68, v68, v32, v32
    v_fma_f32 v70, v70, v34, v34
    v_fma_f32 v72, v72, v36, v36
    v_fma_f32 v74, v74, v38, v38
    v_fma_f32 v76, v76, v40, v40
    v_fma_f32 v78, v78, v42, v42
    v_fma_f32 v80, v80, v44, v44
    v_fma_f32 v82, v82, v46, v46
    v_fma_f32 v61, v61, v25, v25
    v_fma_f32 v63, v63, v27, v27
    v_fma_f32 v65, v65, v29, v29
    v_fma_f32 v67, v67, v31, v31
    v_fma_f32 v69, v69, v33, v33
    v_fma_f32 v71, v71, v35, v35
    v_fma_f32 v73, v73, v37, v37
    v_fma_f32 v75, v75, v39, v39
    v_fma_f32 v77, v77, v41, v41
    v_fma_f32 v79, v79, v43, v43
    v_fma_f32 v81, v81, v45, v45
    v_fma_f32 v83, v83, v47, v47
    v_mul_f32 v60, s46, v60
    v_mul_f32 v62, s46, v62
    v_mul_f32 v64, s46, v64
    v_mul_f32 v66, s46, v66
    v_mul_f32 v68, s46, v68
    v_mul_f32 v70, s46, v70
    v_mul_f32 v72, s46, v72
    v_mul_f32 v74, s46, v74
    v_mul_f32 v76, s46, v76
    v_mul_f32 v78, s46, v78
    v_mul_f32 v80, s46, v80
    v_mul_f32 v82, s46, v82
    v_mul_f32 v61, s46, v61
    v_mul_f32 v63, s46, v63
    v_mul_f32 v65, s46, v65
    v_mul_f32 v67, s46, v67
    v_mul_f32 v69, s46, v69
    v_mul_f32 v71, s46, v71
    v_mul_f32 v73, s46, v73
    v_mul_f32 v75, s46, v75
    v_mul_f32 v77, s46, v77
    v_mul_f32 v79, s46, v79
    v_mul_f32 v81, s46, v81
    v_mul_f32 v83, s46, v83
    v_exp_f32 v60, v60
    v_exp_f32 v62, v62
    v_exp_f32 v64, v64
    v_exp_f32 v66, v66
    v_exp_f32 v68, v68
    v_exp_f32 v70, v70
    v_exp_f32 v72, v72
    v_exp_f32 v74, v74
    v_exp_f32 v76, v76
    v_exp_f32 v78, v78
    v_exp_f32 v80, v80
    v_exp_f32 v82, v82
    v_exp_f32 v61, v61
    v_exp_f32 v63, v63
    v_exp_f32 v65, v65
    v_exp_f32 v67, v67
    v_exp_f32 v69, v69
    v_exp_f32 v71, v71
    v_exp_f32 v73, v73
    v_exp_f32 v75, v75
    v_exp_f32 v77, v77
    v_exp_f32 v79, v79
    v_exp_f32 v81, v81
    v_exp_f32 v83, v83
    v_add_f32 v60, 1.0, v60
    v_add_f32 v62, 1.0, v62
    v_add_f32 v64, 1.0, v64
    v_add_f32 v66, 1.0, v66
    v_add_f32 v68, 1.0, v68
    v_add_f32 v70, 1.0, v70
    v_add_f32 v72, 1.0, v72
    v_add_f32 v74, 1.0, v74
    v_add_f32 v76, 1.0, v76
    v_add_f32 v78, 1.0, v78
    v_add_f32 v80, 1.0, v80
    v_add_f32 v82, 1.0, v82
    v_add_f32 v61, 1.0, v61
    v_add_f32 v63, 1.0, v63
    v_add_f32 v65, 1.0, v65
    v_add_f32 v67, 1.0, v67
    v_add_f32 v69, 1.0, v69
    v_add_f32 v71, 1.0, v71
    v_add_f32 v73, 1.0, v73
    v_add_f32 v75, 1.0, v75
    v_add_f32 v77, 1.0, v77
    v_add_f32 v79, 1.0, v79
    v_add_f32 v81, 1.0, v81
    v_add_f32 v83, 1.0, v83
    v_rcp_f32 v60, v60
    v_rcp_f32 v62, v62
    v_rcp_f32 v64, v64
    v_rcp_f32 v66, v66
    v_rcp_f32 v68, v68
    v_rcp_f32 v70, v70
    v_rcp_f32 v72, v72
    v_rcp_f32 v74, v74
    v_rcp_f32 v76, v76
    v_rcp_f32 v78, v78
    v_rcp_f32 v80, v80
    v_rcp_f32 v82, v82
    v_rcp_f32 v61, v61
    v_rcp_f32 v63, v63
    v_rcp_f32 v65, v65
    v_rcp_f32 v67, v67
    v_rcp_f32 v69, v69
    v_rcp_f32 v71, v71
    v_rcp_f32 v73, v73
    v_rcp_f32 v75, v75
    v_rcp_f32 v77, v77
    v_rcp_f32 v79, v79
    v_rcp_f32 v81, v81
    v_rcp_f32 v83, v83
    v_mul_f32 v24, v24, v60
    v_mul_f32 v26, v26, v62
    v_mul_f32 v28, v28, v64
    v_mul_f32 v30, v30, v66
    v_mul_f32 v32, v32, v68
    v_mul_f32 v34, v34, v70
    v_mul_f32 v36, v36, v72
    v_mul_f32 v38, v38, v74
    v_mul_f32 v40, v40, v76
    v_mul_f32 v42, v42, v78
    v_mul_f32 v44, v44, v80
    v_mul_f32 v46, v46, v82
    v_mul_f32 v25, v25, v61
    v_mul_f32 v27, v27, v63
    v_mul_f32 v29, v29, v65
    v_mul_f32 v31, v31, v67
    v_mul_f32 v33, v33, v69
    v_mul_f32 v35, v35, v71
    v_mul_f32 v37, v37, v73
    v_mul_f32 v39, v39, v75
    v_mul_f32 v41, v41, v77
    v_mul_f32 v43, v43, v79
    v_mul_f32 v45, v45, v81
    v_mul_f32 v47, v47, v83
    v_cvt_pk_bf16_f32 v60, v24, v25
    v_cvt_pk_bf16_f32 v61, v26, v27
    v_cvt_pk_bf16_f32 v64, v28, v29
    v_cvt_pk_bf16_f32 v65, v30, v31
    v_cvt_pk_bf16_f32 v68, v32, v33
    v_cvt_pk_bf16_f32 v69, v34, v35
    v_cvt_pk_bf16_f32 v72, v36, v37
    v_cvt_pk_bf16_f32 v73, v38, v39
    v_cvt_pk_bf16_f32 v76, v40, v41
    v_cvt_pk_bf16_f32 v77, v42, v43
    v_cvt_pk_bf16_f32 v80, v44, v45
    v_cvt_pk_bf16_f32 v81, v46, v47
    v_add_u32 v12, 0, v9
    v_cmp_gt_u32 vcc, 1376, v12
    s_nop 0
    s_and_saveexec_b64 s[48:49], vcc
    buffer_store_dwordx2 v[60:61], v10, s[28:31], 0 offen offset:0
    s_mov_b32 s44, 40960
    buffer_store_dwordx2 v[64:65], v10, s[28:31], s44 offen offset:3072
    s_mov_b64 exec, s[48:49]
    v_add_u32 v12, 16, v9
    v_cmp_gt_u32 vcc, 1376, v12
    s_nop 0
    s_and_saveexec_b64 s[48:49], vcc
    buffer_store_dwordx2 v[68:69], v10, s[28:31], 0 offen offset:32
    s_mov_b32 s44, 40960
    buffer_store_dwordx2 v[72:73], v10, s[28:31], s44 offen offset:3104
    s_mov_b64 exec, s[48:49]
    v_add_u32 v12, 32, v9
    v_cmp_gt_u32 vcc, 1376, v12
    s_nop 0
    s_and_saveexec_b64 s[48:49], vcc
    buffer_store_dwordx2 v[76:77], v10, s[28:31], 0 offen offset:64
    s_mov_b32 s44, 40960
    buffer_store_dwordx2 v[80:81], v10, s[28:31], s44 offen offset:3136
    s_mov_b64 exec, s[48:49]
k4_kernel_END:
    s_endpgm
.globl k5_kernel
.p2align 8
.type k5_kernel,@function
k5_kernel:
    s_cmp_ge_u32 s2, 256
    s_cbranch_scc1 k5_kernel_END
    s_load_dwordx4 s[12:15], s[0:1], 104
    s_load_dwordx2 s[36:37], s[0:1], 0
    s_load_dwordx4 s[4:7], s[0:1], 72
    s_load_dwordx4 s[8:11], s[0:1], 88
    s_and_b32 s40, s2, 31
    s_lshr_b32 s41, s2, 5
    v_and_b32 v1, 63, v0
    v_lshrrev_b32 v2, 6, v0
    v_and_b32 v5, 15, v0
    v_bfe_u32 v6, v0, 4, 2
    v_lshrrev_b32 v7, 8, v0
    v_bfe_u32 v8, v0, 6, 2
    s_nop 0
    s_nop 0
    v_readfirstlane_b32 s60, v2
    s_waitcnt lgkmcnt(0)
    s_mov_b32 s16, s14
    s_mov_b32 s17, s15
    s_mov_b32 s18, 0x1460000
    s_mov_b32 s19, 0x00020000
    s_lshl_b32 s60, s60, 10
    v_lshrrev_b32 v3, 4, v1
    v_and_b32 v4, 15, v1
    s_mul_i32 s42, s41, 64
    s_mul_i32 s43, s40, 64
    s_mov_b32 s46, 2816
    s_mov_b32 s47, 2752
    s_mov_b32 s48, 0xd00000
    s_mov_b32 s49, 0xf00000
    v_add_u32 v9, 0, v2
    v_subrev_u32 v10, 32, v9
    v_cmp_gt_u32 vcc, 32, v9
    s_nop 1
    v_cndmask_b32 v9, v10, v9, vcc
    v_mul_u32_u24 v10, 4, v9
    v_add_u32 v10, v10, v3
    v_and_b32 v11, 15, v10
    v_xor_b32 v11, v11, v4
    v_add_u32 v12, s42, v10
    v_mul_lo_u32 v12, v12, s46
    v_add_u32 v12, s48, v12
    v_subrev_u32 v13, 64, v10
    v_add_u32 v13, s43, v13
    v_mul_lo_u32 v13, v13, s47
    v_add_u32 v13, s49, v13
    v_cmp_gt_u32 s[50:51], 16, v9
    s_nop 1
    v_cndmask_b32 v12, v13, v12, s[50:51]
    v_lshl_add_u32 v80, v11, 4, v12
    v_cmp_le_u32 vcc, 12, v11
    s_nop 0
    s_andn2_b64 vcc, vcc, s[50:51]
    v_mov_b32 v13, 0x40000000
    v_cndmask_b32 v13, 0, v13, vcc
    v_add_u32 v84, v80, v13
    v_add_u32 v9, 8, v2
    v_subrev_u32 v10, 32, v9
    v_cmp_gt_u32 vcc, 32, v9
    s_nop 1
    v_cndmask_b32 v9, v10, v9, vcc
    v_mul_u32_u24 v10, 4, v9
    v_add_u32 v10, v10, v3
    v_and_b32 v11, 15, v10
    v_xor_b32 v11, v11, v4
    v_add_u32 v12, s42, v10
    v_mul_lo_u32 v12, v12, s46
    v_add_u32 v12, s48, v12
    v_subrev_u32 v13, 64, v10
    v_add_u32 v13, s43, v13
    v_mul_lo_u32 v13, v13, s47
    v_add_u32 v13, s49, v13
    v_cmp_gt_u32 s[50:51], 16, v9
    s_nop 1
    v_cndmask_b32 v12, v13, v12, s[50:51]
    v_lshl_add_u32 v81, v11, 4, v12
    v_cmp_le_u32 vcc, 12, v11
    s_nop 0
    s_andn2_b64 vcc, vcc, s[50:51]
    v_mov_b32 v13, 0x40000000
    v_cndmask_b32 v13, 0, v13, vcc
    v_add_u32 v85, v81, v13
    v_add_u32 v9, 16, v2
    v_subrev_u32 v10, 32, v9
    v_cmp_gt_u32 vcc, 32, v9
    s_nop 1
    v_cndmask_b32 v9, v10, v9, vcc
    v_mul_u32_u24 v10, 4, v9
    v_add_u32 v10, v10, v3
    v_and_b32 v11, 15, v10
    v_xor_b32 v11, v11, v4
    v_add_u32 v12, s42, v10
    v_mul_lo_u32 v12, v12, s46
    v_add_u32 v12, s48, v12
    v_subrev_u32 v13, 64, v10
    v_add_u32 v13, s43, v13
    v_mul_lo_u32 v13, v13, s47
    v_add_u32 v13, s49, v13
    v_cmp_gt_u32 s[50:51], 16, v9
    s_nop 1
    v_cndmask_b32 v12, v13, v12, s[50:51]
    v_lshl_add_u32 v82, v11, 4, v12
    v_cmp_le_u32 vcc, 12, v11
    s_nop 0
    s_andn2_b64 vcc, vcc, s[50:51]
    v_mov_b32 v13, 0x40000000
    v_cndmask_b32 v13, 0, v13, vcc
    v_add_u32 v86, v82, v13
    v_add_u32 v9, 24, v2
    v_subrev_u32 v10, 32, v9
    v_cmp_gt_u32 vcc, 32, v9
    s_nop 1
    v_cndmask_b32 v9, v10, v9, vcc
    v_mul_u32_u24 v10, 4, v9
    v_add_u32 v10, v10, v3
    v_and_b32 v11, 15, v10
    v_xor_b32 v11, v11, v4
    v_add_u32 v12, s42, v10
    v_mul_lo_u32 v12, v12, s46
    v_add_u32 v12, s48, v12
    v_subrev_u32 v13, 64, v10
    v_add_u32 v13, s43, v13
    v_mul_lo_u32 v13, v13, s47
    v_add_u32 v13, s49, v13
    v_cmp_gt_u32 s[50:51], 16, v9
    s_nop 1
    v_cndmask_b32 v12, v13, v12, s[50:51]
    v_lshl_add_u32 v83, v11, 4, v12
    v_cmp_le_u32 vcc, 12, v11
    s_nop 0
    s_andn2_b64 vcc, vcc, s[50:51]
    v_mov_b32 v13, 0x40000000
    v_cndmask_b32 v13, 0, v13, vcc
    v_add_u32 v87, v83, v13
    s_add_u32 s64, s60, 0
    s_cmp_ge_u32 s64, 32768
    s_cselect_b32 s52, 32768, 0
    s_sub_u32 s64, s64, s52
    s_add_u32 s65, s60, 8192
    s_cmp_ge_u32 s65, 32768
    s_cselect_b32 s52, 32768, 0
    s_sub_u32 s65, s65, s52
    s_add_u32 s66, s60, 16384
    s_cmp_ge_u32 s66, 32768
    s_cselect_b32 s52, 32768, 0
    s_sub_u32 s66, s66, s52
    s_add_u32 s67, s60, 24576
    s_cmp_ge_u32 s67, 32768
    s_cselect_b32 s52, 32768, 0
    s_sub_u32 s67, s67, s52
    s_add_u32 m0, s64, 0
    s_mov_b32 s44, 0
    buffer_load_dwordx4 v80, s[16:19], s44 offen lds
    s_add_u32 m0, s65, 0
    s_mov_b32 s44, 0
    buffer_load_dwordx4 v81, s[16:19], s44 offen lds
    s_add_u32 m0, s66, 0
    s_mov_b32 s44, 0
    buffer_load_dwordx4 v82, s[16:19], s44 offen lds
    s_add_u32 m0, s67, 0
    s_mov_b32 s44, 0
    buffer_load_dwordx4 v83, s[16:19], s44 offen lds
    v_and_b32 v9, 15, v5
    v_xor_b32 v9, v9, v6
    v_xor_b32 v9, 0, v9
    v_lshlrev_b32 v9, 4, v9
    v_mul_u32_u24 v10, 32, v7
    v_add_u32 v10, v10, v5
    v_mul_u32_u24 v10, 256, v10
    v_add_u32 v88, v9, v10
    v_mul_u32_u24 v10, 16, v8
    v_add_u32 v10, v10, v5
    v_mul_u32_u24 v10, 256, v10
    v_add_u32 v10, v9, v10
    v_add_u32 v92, 16384, v10
    v_add_u32 v96, 0x10000, v88
    v_add_u32 v100, 0x10000, v92
    v_add_u32 v104, 0x20000, v88
    v_add_u32 v108, 0x20000, v92
    v_and_b32 v9, 15, v5
    v_xor_b32 v9, v9, v6
    v_xor_b32 v9, 4, v9
    v_lshlrev_b32 v9, 4, v9
    v_mul_u32_u24 v10, 32, v7
    v_add_u32 v10, v10, v5
    v_mul_u32_u24 v10, 256, v10
    v_add_u32 v89, v9, v10
    v_mul_u32_u24 v10, 16, v8
    v_add_u32 v10, v10, v5
    v_mul_u32_u24 v10, 256, v10
    v_add_u32 v10, v9, v10
    v_add_u32 v93, 16384, v10
    v_add_u32 v97, 0x10000, v89
    v_add_u32 v101, 0x10000, v93
    v_add_u32 v105, 0x20000, v89
    v_add_u32 v109, 0x20000, v93
    v_and_b32 v9, 15, v5
    v_xor_b32 v9, v9, v6
    v_xor_b32 v9, 8, v9
    v_lshlrev_b32 v9, 4, v9
    v_mul_u32_u24 v10, 32, v7
    v_add_u32 v10, v10, v5
    v_mul_u32_u24 v10, 256, v10
    v_add_u32 v90, v9, v10
    v_mul_u32_u24 v10, 16, v8
    v_add_u32 v10, v10, v5
    v_mul_u32_u24 v10, 256, v10
    v_add_u32 v10, v9, v10
    v_add_u32 v94, 16384, v10
    v_add_u32 v98, 0x10000, v90
    v_add_u32 v102, 0x10000, v94
    v_add_u32 v106, 0x20000, v90
    v_add_u32 v110, 0x20000, v94
    v_and_b32 v9, 15, v5
    v_xor_b32 v9, v9, v6
    v_xor_b32 v9, 12, v9
    v_lshlrev_b32 v9, 4, v9
    v_mul_u32_u24 v10, 32, v7
    v_add_u32 v10, v10, v5
    v_mul_u32_u24 v10, 256, v10
    v_add_u32 v91, v9, v10
    v_mul_u32_u24 v10, 16, v8
    v_add_u32 v10, v10, v5
    v_mul_u32_u24 v10, 256, v10
    v_add_u32 v10, v9, v10
    v_add_u32 v95, 16384, v10
    v_add_u32 v99, 0x10000, v91
    v_add_u32 v103, 0x10000, v95
    v_add_u32 v107, 0x20000, v91
    v_add_u32 v111, 0x20000, v95
    v_mov_b32 v24, 0
    v_mov_b32 v25, 0
    v_mov_b32 v26, 0
    v_mov_b32 v27, 0
    v_mov_b32 v28, 0
    v_mov_b32 v29, 0
    v_mov_b32 v30, 0
    v_mov_b32 v31, 0
    s_mov_b32 s24, s8
    s_mov_b32 s25, s9
    s_mov_b32 s26, 0x400
    s_mov_b32 s27, 0x00020000
    s_add_u32 s28, s14, 0x700000
    s_addc_u32 s29, s15, 0
    s_mov_b32 s30, 0x200000
    s_mov_b32 s31, 0x00020000
    s_mov_b32 s32, s10
    s_mov_b32 s33, s11
    s_mov_b32 s34, 0x200000
    s_mov_b32 s35, 0x00020000
    s_mul_i32 s42, s41, 64
    v_mul_u32_u24 v9, 32, v7
    v_lshl_add_u32 v9, v6, 2, v9
    v_add_u32 v9, s42, v9
    s_mul_i32 s42, s40, 64
    v_mul_u32_u24 v10, 16, v8
    v_add_u32 v10, v10, v5
    v_add_u32 v10, s42, v10
    v_lshlrev_b32 v10, 10, v10
    v_lshlrev_b32 v11, 1, v9
    v_add_u32 v10, v10, v11
    buffer_load_dwordx2 v[120:121], v11, s[24:27], 0 offen offset:0
    buffer_load_dwordx2 v[122:123], v11, s[24:27], 0 offen offset:32
    buffer_load_dwordx2 v[124:125], v10, s[28:31], 0 offen offset:0
    buffer_load_dwordx2 v[126:127], v10, s[28:31], 0 offen offset:32
    s_add_u32 m0, s64, 32768
    s_mov_b32 s44, 256
    buffer_load_dwordx4 v80, s[16:19], s44 offen lds
    s_add_u32 m0, s65, 32768
    s_mov_b32 s44, 256
    buffer_load_dwordx4 v81, s[16:19], s44 offen lds
    s_add_u32 m0, s66, 32768
    s_mov_b32 s44, 256
    buffer_load_dwordx4 v82, s[16:19], s44 offen lds
    s_add_u32 m0, s67, 32768
    s_mov_b32 s44, 256
    buffer_load_dwordx4 v83, s[16:19], s44 offen lds
    s_add_u32 m0, s64, 65536
    s_mov_b32 s44, 512
    buffer_load_dwordx4 v80, s[16:19], s44 offen lds
    s_add_u32 m0, s65, 65536
    s_mov_b32 s44, 512
    buffer_load_dwordx4 v81, s[16:19], s44 offen lds
    s_add_u32 m0, s66, 65536
    s_mov_b32 s44, 512
    buffer_load_dwordx4 v82, s[16:19], s44 offen lds
    s_add_u32 m0, s67, 65536
    s_mov_b32 s44, 512
    buffer_load_dwordx4 v83, s[16:19], s44 offen lds
    s_waitcnt vmcnt(12)
    s_barrier
    ds_read_b128 v[32:35], v88 offset:0
    ds_read_b128 v[36:39], v88 offset:4096
    ds_read_b128 v[40:43], v92 offset:0
    ds_read_b128 v[44:47], v89 offset:0
    ds_read_b128 v[48:51], v89 offset:4096
    ds_read_b128 v[52:55], v93 offset:0
    ds_read_b128 v[56:59], v90 offset:0
    ds_read_b128 v[60:63], v90 offset:4096
    ds_read_b128 v[64:67], v94 offset:0
    ds_read_b128 v[68:71], v91 offset:0
    ds_read_b128 v[72:75], v91 offset:4096
    ds_read_b128 v[76:79], v95 offset:0
    s_waitcnt lgkmcnt(9)
    v_mfma_f32_16x16x32_bf16 v[24:27], v[32:35], v[40:43], v[24:27]
    s_add_u32 m0, s64, 98304
    s_mov_b32 s44, 768
    buffer_load_dwordx4 v80, s[16:19], s44 offen lds
    v_mfma_f32_16x16x32_bf16 v[28:31], v[36:39], v[40:43], v[28:31]
    s_waitcnt lgkmcnt(6)
    v_mfma_f32_16x16x32_bf16 v[24:27], v[44:47], v[52:55], v[24:27]
    s_add_u32 m0, s65, 98304
    s_mov_b32 s44, 768
    buffer_load_dwordx4 v81, s[16:19], s44 offen lds
    v_mfma_f32_16x16x32_bf16 v[28:31], v[48:51], v[52:55], v[28:31]
    s_waitcnt lgkmcnt(3)
    v_mfma_f32_16x16x32_bf16 v[24:27], v[56:59], v[64:67], v[24:27]
    s_add_u32 m0, s66, 98304
    s_mov_b32 s44, 768
    buffer_load_dwordx4 v82, s[16:19], s44 offen lds
    v_mfma_f32_16x16x32_bf16 v[28:31], v[60:63], v[64:67], v[28:31]
    s_waitcnt lgkmcnt(0)
    v_mfma_f32_16x16x32_bf16 v[24:27], v[68:71], v[76:79], v[24:27]
    s_add_u32 m0, s67, 98304
    s_mov_b32 s44, 768
    buffer_load_dwordx4 v83, s[16:19], s44 offen lds
    v_mfma_f32_16x16x32_bf16 v[28:31], v[72:75], v[76:79], v[28:31]
    s_waitcnt vmcnt(8)
    s_barrier
    ds_read_b128 v[32:35], v88 offset:32768
    ds_read_b128 v[36:39], v88 offset:36864
    ds_read_b128 v[40:43], v92 offset:32768
    ds_read_b128 v[44:47], v89 offset:32768
    ds_read_b128 v[48:51], v89 offset:36864
    ds_read_b128 v[52:55], v93 offset:32768
    ds_read_b128 v[56:59], v90 offset:32768
    ds_read_b128 v[60:63], v90 offset:36864
    ds_read_b128 v[64:67], v94 offset:32768
    ds_read_b128 v[68:71], v91 offset:32768
    ds_read_b128 v[72:75], v91 offset:36864
    ds_read_b128 v[76:79], v95 offset:32768
    s_waitcnt lgkmcnt(9)
    v_mfma_f32_16x16x32_bf16 v[24:27], v[32:35], v[40:43], v[24:27]
    s_add_u32 m0, s64, 0
    s_mov_b32 s44, 1024
    buffer_load_dwordx4 v80, s[16:19], s44 offen lds
    v_mfma_f32_16x16x32_bf16 v[28:31], v[36:39], v[40:43], v[28:31]
    s_waitcnt lgkmcnt(6)
    v_mfma_f32_16x16x32_bf16 v[24:27], v[44:47], v[52:55], v[24:27]
    s_add_u32 m0, s65, 0
    s_mov_b32 s44, 1024
    buffer_load_dwordx4 v81, s[16:19], s44 offen lds
    v_mfma_f32_16x16x32_bf16 v[28:31], v[48:51], v[52:55], v[28:31]
    s_waitcnt lgkmcnt(3)
    v_mfma_f32_16x16x32_bf16 v[24:27], v[56:59], v[64:67], v[24:27]
    s_add_u32 m0, s66, 0
    s_mov_b32 s44, 1024
    buffer_load_dwordx4 v82, s[16:19], s44 offen lds
    v_mfma_f32_16x16x32_bf16 v[28:31], v[60:63], v[64:67], v[28:31]
    s_waitcnt lgkmcnt(0)
    v_mfma_f32_16x16x32_bf16 v[24:27], v[68:71], v[76:79], v[24:27]
    s_add_u32 m0, s67, 0
    s_mov_b32 s44, 1024
    buffer_load_dwordx4 v83, s[16:19], s44 offen lds
    v_mfma_f32_16x16x32_bf16 v[28:31], v[72:75], v[76:79], v[28:31]
    s_waitcnt vmcnt(8)
    s_barrier
    ds_read_b128 v[32:35], v96 offset:0
    ds_read_b128 v[36:39], v96 offset:4096
    ds_read_b128 v[40:43], v100 offset:0
    ds_read_b128 v[44:47], v97 offset:0
    ds_read_b128 v[48:51], v97 offset:4096
    ds_read_b128 v[52:55], v101 offset:0
    ds_read_b128 v[56:59], v98 offset:0
    ds_read_b128 v[60:63], v98 offset:4096
    ds_read_b128 v[64:67], v102 offset:0
    ds_read_b128 v[68:71], v99 offset:0
    ds_read_b128 v[72:75], v99 offset:4096
    ds_read_b128 v[76:79], v103 offset:0
    s_waitcnt lgkmcnt(9)
    v_mfma_f32_16x16x32_bf16 v[24:27], v[32:35], v[40:43], v[24:27]
    s_add_u32 m0, s64, 32768
    s_mov_b32 s44, 1280
    buffer_load_dwordx4 v80, s[16:19], s44 offen lds
    v_mfma_f32_16x16x32_bf16 v[28:31], v[36:39], v[40:43], v[28:31]
    s_waitcnt lgkmcnt(6)
    v_mfma_f32_16x16x32_bf16 v[24:27], v[44:47], v[52:55], v[24:27]
    s_add_u32 m0, s65, 32768
    s_mov_b32 s44, 1280
    buffer_load_dwordx4 v81, s[16:19], s44 offen lds
    v_mfma_f32_16x16x32_bf16 v[28:31], v[48:51], v[52:55], v[28:31]
    s_waitcnt lgkmcnt(3)
    v_mfma_f32_16x16x32_bf16 v[24:27], v[56:59], v[64:67], v[24:27]
    s_add_u32 m0, s66, 32768
    s_mov_b32 s44, 1280
    buffer_load_dwordx4 v82, s[16:19], s44 offen lds
    v_mfma_f32_16x16x32_bf16 v[28:31], v[60:63], v[64:67], v[28:31]
    s_waitcnt lgkmcnt(0)
    v_mfma_f32_16x16x32_bf16 v[24:27], v[68:71], v[76:79], v[24:27]
    s_add_u32 m0, s67, 32768
    s_mov_b32 s44, 1280
    buffer_load_dwordx4 v83, s[16:19], s44 offen lds
    v_mfma_f32_16x16x32_bf16 v[28:31], v[72:75], v[76:79], v[28:31]
    s_waitcnt vmcnt(8)
    s_barrier
    ds_read_b128 v[32:35], v96 offset:32768
    ds_read_b128 v[36:39], v96 offset:36864
    ds_read_b128 v[40:43], v100 offset:32768
    ds_read_b128 v[44:47], v97 offset:32768
    ds_read_b128 v[48:51], v97 offset:36864
    ds_read_b128 v[52:55], v101 offset:32768
    ds_read_b128 v[56:59], v98 offset:32768
    ds_read_b128 v[60:63], v98 offset:36864
    ds_read_b128 v[64:67], v102 offset:32768
    ds_read_b128 v[68:71], v99 offset:32768
    ds_read_b128 v[72:75], v99 offset:36864
    ds_read_b128 v[76:79], v103 offset:32768
    s_waitcnt lgkmcnt(9)
    v_mfma_f32_16x16x32_bf16 v[24:27], v[32:35], v[40:43], v[24:27]
    s_add_u32 m0, s64, 65536
    s_mov_b32 s44, 1536
    buffer_load_dwordx4 v80, s[16:19], s44 offen lds
    v_mfma_f32_16x16x32_bf16 v[28:31], v[36:39], v[40:43], v[28:31]
    s_waitcnt lgkmcnt(6)
    v_mfma_f32_16x16x32_bf16 v[24:27], v[44:47], v[52:55], v[24:27]
    s_add_u32 m0, s65, 65536
    s_mov_b32 s44, 1536
    buffer_load_dwordx4 v81, s[16:19], s44 offen lds
    v_mfma_f32_16x16x32_bf16 v[28:31], v[48:51], v[52:55], v[28:31]
    s_waitcnt lgkmcnt(3)
    v_mfma_f32_16x16x32_bf16 v[24:27], v[56:59], v[64:67], v[24:27]
    s_add_u32 m0, s66, 65536
    s_mov_b32 s44, 1536
    buffer_load_dwordx4 v82, s[16:19], s44 offen lds
    v_mfma_f32_16x16x32_bf16 v[28:31], v[60:63], v[64:67], v[28:31]
    s_waitcnt lgkmcnt(0)
    v_mfma_f32_16x16x32_bf16 v[24:27], v[68:71], v[76:79], v[24:27]
    s_add_u32 m0, s67, 65536
    s_mov_b32 s44, 1536
    buffer_load_dwordx4 v83, s[16:19], s44 offen lds
    v_mfma_f32_16x16x32_bf16 v[28:31], v[72:75], v[76:79], v[28:31]
    s_waitcnt vmcnt(8)
    s_barrier
    ds_read_b128 v[32:35], v88 offset:0
    ds_read_b128 v[36:39], v88 offset:4096
    ds_read_b128 v[40:43], v92 offset:0
    ds_read_b128 v[44:47], v89 offset:0
    ds_read_b128 v[48:51], v89 offset:4096
    ds_read_b128 v[52:55], v93 offset:0
    ds_read_b128 v[56:59], v90 offset:0
    ds_read_b128 v[60:63], v90 offset:4096
    ds_read_b128 v[64:67], v94 offset:0
    ds_read_b128 v[68:71], v91 offset:0
    ds_read_b128 v[72:75], v91 offset:4096
    ds_read_b128 v[76:79], v95 offset:0
    s_waitcnt lgkmcnt(9)
    v_mfma_f32_16x16x32_bf16 v[24:27], v[32:35], v[40:43], v[24:27]
    s_add_u32 m0, s64, 98304
    s_mov_b32 s44, 1792
    buffer_load_dwordx4 v80, s[16:19], s44 offen lds
    v_mfma_f32_16x16x32_bf16 v[28:31], v[36:39], v[40:43], v[28:31]
    s_waitcnt lgkmcnt(6)
    v_mfma_f32_16x16x32_bf16 v[24:27], v[44:47], v[52:55], v[24:27]
    s_add_u32 m0, s65, 98304
    s_mov_b32 s44, 1792
    buffer_load_dwordx4 v81, s[16:19], s44 offen lds
    v_mfma_f32_16x16x32_bf16 v[28:31], v[48:51], v[52:55], v[28:31]
    s_waitcnt lgkmcnt(3)
    v_mfma_f32_16x16x32_bf16 v[24:27], v[56:59], v[64:67], v[24:27]
    s_add_u32 m0, s66, 98304
    s_mov_b32 s44, 1792
    buffer_load_dwordx4 v82, s[16:19], s44 offen lds
    v_mfma_f32_16x16x32_bf16 v[28:31], v[60:63], v[64:67], v[28:31]
    s_waitcnt lgkmcnt(0)
    v_mfma_f32_16x16x32_bf16 v[24:27], v[68:71], v[76:79], v[24:27]
    s_add_u32 m0, s67, 98304
    s_mov_b32 s44, 1792
    buffer_load_dwordx4 v83, s[16:19], s44 offen lds
    v_mfma_f32_16x16x32_bf16 v[28:31], v[72:75], v[76:79], v[28:31]
    s_waitcnt vmcnt(8)
    s_barrier
    ds_read_b128 v[32:35], v88 offset:32768
    ds_read_b128 v[36:39], v88 offset:36864
    ds_read_b128 v[40:43], v92 offset:32768
    ds_read_b128 v[44:47], v89 offset:32768
    ds_read_b128 v[48:51], v89 offset:36864
    ds_read_b128 v[52:55], v93 offset:32768
    ds_read_b128 v[56:59], v90 offset:32768
    ds_read_b128 v[60:63], v90 offset:36864
    ds_read_b128 v[64:67], v94 offset:32768
    ds_read_b128 v[68:71], v91 offset:32768
    ds_read_b128 v[72:75], v91 offset:36864
    ds_read_b128 v[76:79], v95 offset:32768
    s_waitcnt lgkmcnt(9)
    v_mfma_f32_16x16x32_bf16 v[24:27], v[32:35], v[40:43], v[24:27]
    s_add_u32 m0, s64, 0
    s_mov_b32 s44, 2048
    buffer_load_dwordx4 v80, s[16:19], s44 offen lds
    v_mfma_f32_16x16x32_bf16 v[28:31], v[36:39], v[40:43], v[28:31]
    s_waitcnt lgkmcnt(6)
    v_mfma_f32_16x16x32_bf16 v[24:27], v[44:47], v[52:55], v[24:27]
    s_add_u32 m0, s65, 0
    s_mov_b32 s44, 2048
    buffer_load_dwordx4 v81, s[16:19], s44 offen lds
    v_mfma_f32_16x16x32_bf16 v[28:31], v[48:51], v[52:55], v[28:31]
    s_waitcnt lgkmcnt(3)
    v_mfma_f32_16x16x32_bf16 v[24:27], v[56:59], v[64:67], v[24:27]
    s_add_u32 m0, s66, 0
    s_mov_b32 s44, 2048
    buffer_load_dwordx4 v82, s[16:19], s44 offen lds
    v_mfma_f32_16x16x32_bf16 v[28:31], v[60:63], v[64:67], v[28:31]
    s_waitcnt lgkmcnt(0)
    v_mfma_f32_16x16x32_bf16 v[24:27], v[68:71], v[76:79], v[24:27]
    s_add_u32 m0, s67, 0
    s_mov_b32 s44, 2048
    buffer_load_dwordx4 v83, s[16:19], s44 offen lds
    v_mfma_f32_16x16x32_bf16 v[28:31], v[72:75], v[76:79], v[28:31]
    s_waitcnt vmcnt(8)
    s_barrier
    ds_read_b128 v[32:35], v96 offset:0
    ds_read_b128 v[36:39], v96 offset:4096
    ds_read_b128 v[40:43], v100 offset:0
    ds_read_b128 v[44:47], v97 offset:0
    ds_read_b128 v[48:51], v97 offset:4096
    ds_read_b128 v[52:55], v101 offset:0
    ds_read_b128 v[56:59], v98 offset:0
    ds_read_b128 v[60:63], v98 offset:4096
    ds_read_b128 v[64:67], v102 offset:0
    ds_read_b128 v[68:71], v99 offset:0
    ds_read_b128 v[72:75], v99 offset:4096
    ds_read_b128 v[76:79], v103 offset:0
    s_waitcnt lgkmcnt(9)
    v_mfma_f32_16x16x32_bf16 v[24:27], v[32:35], v[40:43], v[24:27]
    s_add_u32 m0, s64, 32768
    s_mov_b32 s44, 2304
    buffer_load_dwordx4 v80, s[16:19], s44 offen lds
    v_mfma_f32_16x16x32_bf16 v[28:31], v[36:39], v[40:43], v[28:31]
    s_waitcnt lgkmcnt(6)
    v_mfma_f32_16x16x32_bf16 v[24:27], v[44:47], v[52:55], v[24:27]
    s_add_u32 m0, s65, 32768
    s_mov_b32 s44, 2304
    buffer_load_dwordx4 v81, s[16:19], s44 offen lds
    v_mfma_f32_16x16x32_bf16 v[28:31], v[48:51], v[52:55], v[28:31]
    s_waitcnt lgkmcnt(3)
    v_mfma_f32_16x16x32_bf16 v[24:27], v[56:59], v[64:67], v[24:27]
    s_add_u32 m0, s66, 32768
    s_mov_b32 s44, 2304
    buffer_load_dwordx4 v82, s[16:19], s44 offen lds
    v_mfma_f32_16x16x32_bf16 v[28:31], v[60:63], v[64:67], v[28:31]
    s_waitcnt lgkmcnt(0)
    v_mfma_f32_16x16x32_bf16 v[24:27], v[68:71], v[76:79], v[24:27]
    s_add_u32 m0, s67, 32768
    s_mov_b32 s44, 2304
    buffer_load_dwordx4 v83, s[16:19], s44 offen lds
    v_mfma_f32_16x16x32_bf16 v[28:31], v[72:75], v[76:79], v[28:31]
    s_waitcnt vmcnt(8)
    s_barrier
    ds_read_b128 v[32:35], v96 offset:32768
    ds_read_b128 v[36:39], v96 offset:36864
    ds_read_b128 v[40:43], v100 offset:32768
    ds_read_b128 v[44:47], v97 offset:32768
    ds_read_b128 v[48:51], v97 offset:36864
    ds_read_b128 v[52:55], v101 offset:32768
    ds_read_b128 v[56:59], v98 offset:32768
    ds_read_b128 v[60:63], v98 offset:36864
    ds_read_b128 v[64:67], v102 offset:32768
    ds_read_b128 v[68:71], v99 offset:32768
    ds_read_b128 v[72:75], v99 offset:36864
    ds_read_b128 v[76:79], v103 offset:32768
    s_waitcnt lgkmcnt(9)
    v_mfma_f32_16x16x32_bf16 v[24:27], v[32:35], v[40:43], v[24:27]
    s_add_u32 m0, s64, 65536
    s_mov_b32 s44, 2560
    buffer_load_dwordx4 v84, s[16:19], s44 offen lds
    v_mfma_f32_16x16x32_bf16 v[28:31], v[36:39], v[40:43], v[28:31]
    s_waitcnt lgkmcnt(6)
    v_mfma_f32_16x16x32_bf16 v[24:27], v[44:47], v[52:55], v[24:27]
    s_add_u32 m0, s65, 65536
    s_mov_b32 s44, 2560
    buffer_load_dwordx4 v85, s[16:19], s44 offen lds
    v_mfma_f32_16x16x32_bf16 v[28:31], v[48:51], v[52:55], v[28:31]
    s_waitcnt lgkmcnt(3)
    v_mfma_f32_16x16x32_bf16 v[24:27], v[56:59], v[64:67], v[24:27]
    s_add_u32 m0, s66, 65536
    s_mov_b32 s44, 2560
    buffer_load_dwordx4 v86, s[16:19], s44 offen lds
    v_mfma_f32_16x16x32_bf16 v[28:31], v[60:63], v[64:67], v[28:31]
    s_waitcnt lgkmcnt(0)
    v_mfma_f32_16x16x32_bf16 v[24:27], v[68:71], v[76:79], v[24:27]
    s_add_u32 m0, s67, 65536
    s_mov_b32 s44, 2560
    buffer_load_dwordx4 v87, s[16:19], s44 offen lds
    v_mfma_f32_16x16x32_bf16 v[28:31], v[72:75], v[76:79], v[28:31]
    s_waitcnt vmcnt(8)
    s_barrier
    ds_read_b128 v[32:35], v88 offset:0
    ds_read_b128 v[36:39], v88 offset:4096
    ds_read_b128 v[40:43], v92 offset:0
    ds_read_b128 v[44:47], v89 offset:0
    ds_read_b128 v[48:51], v89 offset:4096
    ds_read_b128 v[52:55], v93 offset:0
    ds_read_b128 v[56:59], v90 offset:0
    ds_read_b128 v[60:63], v90 offset:4096
    ds_read_b128 v[64:67], v94 offset:0
    ds_read_b128 v[68:71], v91 offset:0
    ds_read_b128 v[72:75], v91 offset:4096
    ds_read_b128 v[76:79], v95 offset:0
    s_waitcnt lgkmcnt(9)
    v_mfma_f32_16x16x32_bf16 v[24:27], v[32:35], v[40:43], v[24:27]
    v_mfma_f32_16x16x32_bf16 v[28:31], v[36:39], v[40:43], v[28:31]
    s_waitcnt lgkmcnt(6)
    v_mfma_f32_16x16x32_bf16 v[24:27], v[44:47], v[52:55], v[24:27]
    v_mfma_f32_16x16x32_bf16 v[28:31], v[48:51], v[52:55], v[28:31]
    s_waitcnt lgkmcnt(3)
    v_mfma_f32_16x16x32_bf16 v[24:27], v[56:59], v[64:67], v[24:27]
    v_mfma_f32_16x16x32_bf16 v[28:31], v[60:63], v[64:67], v[28:31]
    s_waitcnt lgkmcnt(0)
    v_mfma_f32_16x16x32_bf16 v[24:27], v[68:71], v[76:79], v[24:27]
    v_mfma_f32_16x16x32_bf16 v[28:31], v[72:75], v[76:79], v[28:31]
    s_waitcnt vmcnt(4)
    s_barrier
    ds_read_b128 v[32:35], v88 offset:32768
    ds_read_b128 v[36:39], v88 offset:36864
    ds_read_b128 v[40:43], v92 offset:32768
    ds_read_b128 v[44:47], v89 offset:32768
    ds_read_b128 v[48:51], v89 offset:36864
    ds_read_b128 v[52:55], v93 offset:32768
    ds_read_b128 v[56:59], v90 offset:32768
    ds_read_b128 v[60:63], v90 offset:36864
    ds_read_b128 v[64:67], v94 offset:32768
    ds_read_b128 v[68:71], v91 offset:32768
    ds_read_b128 v[72:75], v91 offset:36864
    ds_read_b128 v[76:79], v95 offset:32768
    s_waitcnt lgkmcnt(9)
    v_mfma_f32_16x16x32_bf16 v[24:27], v[32:35], v[40:43], v[24:27]
    v_mfma_f32_16x16x32_bf16 v[28:31], v[36:39], v[40:43], v[28:31]
    s_waitcnt lgkmcnt(6)
    v_mfma_f32_16x16x32_bf16 v[24:27], v[44:47], v[52:55], v[24:27]
    v_mfma_f32_16x16x32_bf16 v[28:31], v[48:51], v[52:55], v[28:31]
    s_waitcnt lgkmcnt(3)
    v_mfma_f32_16x16x32_bf16 v[24:27], v[56:59], v[64:67], v[24:27]
    v_mfma_f32_16x16x32_bf16 v[28:31], v[60:63], v[64:67], v[28:31]
    s_waitcnt lgkmcnt(0)
    v_mfma_f32_16x16x32_bf16 v[24:27], v[68:71], v[76:79], v[24:27]
    v_mfma_f32_16x16x32_bf16 v[28:31], v[72:75], v[76:79], v[28:31]
    s_waitcnt vmcnt(0)
    s_barrier
    ds_read_b128 v[32:35], v96 offset:0
    ds_read_b128 v[36:39], v96 offset:4096
    ds_read_b128 v[40:43], v100 offset:0
    ds_read_b128 v[44:47], v97 offset:0
    ds_read_b128 v[48:51], v97 offset:4096
    ds_read_b128 v[52:55], v101 offset:0
    ds_read_b128 v[56:59], v98 offset:0
    ds_read_b128 v[60:63], v98 offset:4096
    ds_read_b128 v[64:67], v102 offset:0
    ds_read_b128 v[68:71], v99 offset:0
    ds_read_b128 v[72:75], v99 offset:4096
    ds_read_b128 v[76:79], v103 offset:0
    s_waitcnt lgkmcnt(9)
    v_mfma_f32_16x16x32_bf16 v[24:27], v[32:35], v[40:43], v[24:27]
    v_mfma_f32_16x16x32_bf16 v[28:31], v[36:39], v[40:43], v[28:31]
    s_waitcnt lgkmcnt(6)
    v_mfma_f32_16x16x32_bf16 v[24:27], v[44:47], v[52:55], v[24:27]
    v_mfma_f32_16x16x32_bf16 v[28:31], v[48:51], v[52:55], v[28:31]
    s_waitcnt lgkmcnt(3)
    v_mfma_f32_16x16x32_bf16 v[24:27], v[56:59], v[64:67], v[24:27]
    v_mfma_f32_16x16x32_bf16 v[28:31], v[60:63], v[64:67], v[28:31]
    s_waitcnt lgkmcnt(0)
    v_mfma_f32_16x16x32_bf16 v[24:27], v[68:71], v[76:79], v[24:27]
    v_mfma_f32_16x16x32_bf16 v[28:31], v[72:75], v[76:79], v[28:31]
    s_nop 6
    v_cvt_pk_bf16_f32 v32, v24, v25
    v_cvt_pk_bf16_f32 v34, v26, v27
    v_cvt_pk_bf16_f32 v36, v28, v29
    v_cvt_pk_bf16_f32 v38, v30, v31
    v_lshlrev_b32 v24, 16, v32
    v_lshlrev_b32 v26, 16, v34
    v_lshlrev_b32 v28, 16, v36
    v_lshlrev_b32 v30, 16, v38
    v_and_b32 v25, 0xffff0000, v32
    v_and_b32 v27, 0xffff0000, v34
    v_and_b32 v29, 0xffff0000, v36
    v_and_b32 v31, 0xffff0000, v38
    v_lshlrev_b32 v32, 16, v120
    v_lshlrev_b32 v34, 16, v121
    v_lshlrev_b32 v36, 16, v122
    v_lshlrev_b32 v38, 16, v123
    v_and_b32 v33, 0xffff0000, v120
    v_and_b32 v35, 0xffff0000, v121
    v_and_b32 v37, 0xffff0000, v122
    v_and_b32 v39, 0xffff0000, v123
    v_add_f32 v24, v24, v32
    v_add_f32 v26, v26, v34
    v_add_f32 v28, v28, v36
    v_add_f32 v30, v30, v38
    v_add_f32 v25, v25, v33
    v_add_f32 v27, v27, v35
    v_add_f32 v29, v29, v37
    v_add_f32 v31, v31, v39
    v_cvt_pk_bf16_f32 v32, v24, v25
    v_cvt_pk_bf16_f32 v34, v26, v27
    v_cvt_pk_bf16_f32 v36, v28, v29
    v_cvt_pk_bf16_f32 v38, v30, v31
    v_lshlrev_b32 v24, 16, v32
    v_lshlrev_b32 v26, 16, v34
    v_lshlrev_b32 v28, 16, v36
    v_lshlrev_b32 v30, 16, v38
    v_and_b32 v25, 0xffff0000, v32
    v_and_b32 v27, 0xffff0000, v34
    v_and_b32 v29, 0xffff0000, v36
    v_and_b32 v31, 0xffff0000, v38
    v_lshlrev_b32 v32, 16, v124
    v_lshlrev_b32 v34, 16, v125
    v_lshlrev_b32 v36, 16, v126
    v_lshlrev_b32 v38, 16, v127
    v_and_b32 v33, 0xffff0000, v124
    v_and_b32 v35, 0xffff0000, v125
    v_and_b32 v37, 0xffff0000, v126
    v_and_b32 v39, 0xffff0000, v127
    v_add_f32 v24, v24, v32
    v_add_f32 v26, v26, v34
    v_add_f32 v28, v28, v36
    v_add_f32 v30, v30, v38
    v_add_f32 v25, v25, v33
    v_add_f32 v27, v27, v35
    v_add_f32 v29, v29, v37
    v_add_f32 v31, v31, v39
    v_cvt_pk_bf16_f32 v124, v24, v25
    v_cvt_pk_bf16_f32 v125, v26, v27
    v_cvt_pk_bf16_f32 v126, v28, v29
    v_cvt_pk_bf16_f32 v127, v30, v31
    buffer_store_dwordx2 v[124:125], v10, s[32:35], 0 offen offset:0
    buffer_store_dwordx2 v[126:127], v10, s[32:35], 0 offen offset:32
k5_kernel_END:
    s_endpgm

.section .rodata,"a"
.p2align 6
.amdhsa_kernel k2_kernel
  .amdhsa_next_free_vgpr 160
  .amdhsa_next_free_sgpr 100
  .amdhsa_accum_offset 160
  .amdhsa_group_segment_fixed_size 0
  .amdhsa_kernarg_size 120
  .amdhsa_user_sgpr_count 2
  .amdhsa_user_sgpr_kernarg_segment_ptr 1
  .amdhsa_system_sgpr_workgroup_id_x 1
  .amdhsa_float_denorm_mode_32 3
.end_amdhsa_kernel

.p2align 6
.amdhsa_kernel k3_kernel
  .amdhsa_next_free_vgpr 80
  .amdhsa_next_free_sgpr 100
  .amdhsa_accum_offset 80
  .amdhsa_group_segment_fixed_size 0
  .amdhsa_kernarg_size 120
  .amdhsa_user_sgpr_count 2
  .amdhsa_user_sgpr_kernarg_segment_ptr 1
  .amdhsa_system_sgpr_workgroup_id_x 1
  .amdhsa_float_denorm_mode_32 3
.end_amdhsa_kernel

.p2align 6
.amdhsa_kernel k4_kernel
  .amdhsa_next_free_vgpr 144
  .amdhsa_next_free_sgpr 100
  .amdhsa_accum_offset 144
  .amdhsa_group_segment_fixed_size 0
  .amdhsa_kernarg_size 120
  .amdhsa_user_sgpr_count 2
  .amdhsa_user_sgpr_kernarg_segment_ptr 1
  .amdhsa_system_sgpr_workgroup_id_x 1
  .amdhsa_float_denorm_mode_32 3
.end_amdhsa_kernel

.p2align 6
.amdhsa_kernel k5_kernel
  .amdhsa_next_free_vgpr 136
  .amdhsa_next_free_sgpr 100
  .amdhsa_accum_offset 136
  .amdhsa_group_segment_fixed_size 0
  .amdhsa_kernarg_size 120
  .amdhsa_user_sgpr_count 2
  .amdhsa_user_sgpr_kernarg_segment_ptr 1
  .amdhsa_system_sgpr_workgroup_id_x 1
  .amdhsa_float_denorm_mode_32 3
.end_amdhsa_kernel
```
